```python
import torch

def _softmax(x, axis=-1):
    return torch.softmax(x, dim=axis)

def _gelu(x):
    return torch.nn.functional.gelu(x, approximate='tanh')

def _silu(x):
    return torch.nn.functional.silu(x)

def _sigmoid(x):
    return torch.sigmoid(x)

def _layernorm(x, axis=-1, eps=1e-05):
    m = x.mean(dim=axis, keepdim=True)
    v = x.var(dim=axis, keepdim=True, unbiased=False)
    return (x - m) / torch.sqrt(v + eps)

def _scatter_add(tgt, idx, src, axis=0):
    return tgt.clone().index_add_(axis, idx, src)

def _segment_sum(src, seg, n):
    out = torch.zeros((n,) + src.shape[1:], dtype=src.dtype)
    return out.index_add_(0, seg, src)

def _pad(x, pw):
    flat = tuple((v for pair in reversed(pw) for v in pair))
    return torch.nn.functional.pad(x, flat)
kernel_name = 'adaLN_cond__mha_block_cached__geglu_ffn__decode'

def setup_inputs():

    _w = lambda a: (lambda t: t.to(torch.bfloat16) if t.is_floating_point() else t)(torch.as_tensor(a))

    def _A_setup():
        B, Sq, D = (1, 1, 512)
        H, Sk, Dh = (32, 65536, 128)
        return {'x': _w((lambda *s: torch.randn(*s, dtype=torch.bfloat16) * 0.1)(B, Sq, D)), 'k_cache': _w((lambda *s: torch.randn(*s, dtype=torch.bfloat16) * 0.8)(B, H, Sk, Dh)), 'v_cache': _w((lambda *s: torch.randn(*s, dtype=torch.bfloat16) * 1.6)(B, H, Sk, Dh)), 'wq': _w((lambda *s: torch.randn(*s, dtype=torch.bfloat16) * 0.8)(D, H * Dh) * D ** (-0.5)), 'wo': _w((lambda *s: torch.randn(*s, dtype=torch.bfloat16) * 1.6)(H * Dh, D) * (H * Dh) ** (-0.5))}
    _A_in = _A_setup()

    def _B_setup():
        B, S, D, F = (1, 1, 512, 1792)
        return {'x': _w((lambda *s: torch.randn(*s, dtype=torch.bfloat16) * 0.1)(B, S, D)), 'w_gate': _w((lambda *s: torch.randn(*s, dtype=torch.bfloat16) * 0.4)(D, F)), 'w_up': _w((lambda *s: torch.randn(*s, dtype=torch.bfloat16) * 0.4)(D, F)), 'w_down': _w((lambda *s: torch.randn(*s, dtype=torch.bfloat16) * 0.4)(F, D))}
    _B_in = _B_setup()
    return {'A_x': _A_in['x'], 'A_k_cache': _A_in['k_cache'], 'A_v_cache': _A_in['v_cache'], 'A_wq': _A_in['wq'], 'A_wo': _A_in['wo'], 'B_x': _B_in['x'], 'B_w_gate': _B_in['w_gate'], 'B_w_up': _B_in['w_up'], 'B_w_down': _B_in['w_down'], 'c': _w((lambda *s: torch.randn(*s, dtype=torch.bfloat16) * 0.4)(1, 512) * 8.0), 'w_mod': _w((lambda *s: torch.randn(*s, dtype=torch.bfloat16) * 0.4)(512, 6 * 512) * 512 ** (-0.5) * 8.0)}

def reference(A_x, A_k_cache, A_v_cache, A_wq, A_wo, B_x, B_w_gate, B_w_up, B_w_down, c, w_mod):

    def _A_ref(x, k_cache, v_cache, wq, wo):
        B, Sq, D = x.shape
        H, Dh = (32, 128)
        q = (lambda x, *d: x.permute(*d))((x @ wq).reshape(B, Sq, H, Dh), 0, 2, 1, 3)
        scores = torch.einsum('bhqd,bhkd->bhqk', q, k_cache) * Dh ** (-0.5)
        p = _softmax(scores, axis=-1)
        o = torch.einsum('bhqk,bhkd->bhqd', p, v_cache)
        return (lambda x, *d: x.permute(*d))(o, 0, 2, 1, 3).reshape(B, Sq, H * Dh) @ wo

    def _B_ref(x, w_gate, w_up, w_down):
        return _gelu(x @ w_gate) * (x @ w_up) @ w_down
    x = A_x
    mod = (_silu(c) @ w_mod).reshape(c.shape[0], 6, 1, -1)
    sa, ca, ga, sb, cb, gb = (mod[:, 0].clone(), mod[:, 1].clone(), mod[:, 2].clone(), mod[:, 3].clone(), mod[:, 4].clone(), mod[:, 5].clone())
    h = _layernorm(x, axis=-1) * (1 + ca) + sa
    x = x + ga * _A_ref(h, A_k_cache, A_v_cache, A_wq, A_wo)
    h = _layernorm(x, axis=-1) * (1 + cb) + sb
    x = x + gb * _B_ref(h, B_w_gate, B_w_up, B_w_down)
    return x
```

```asm
; @launch grid=(256,1,1) block=(512,1,1) lds=77824
.amdgcn_target "amdgcn-amd-amdhsa--gfx950"
.text
.globl adaLN_cond__mha_block_cached__geglu_ffn__decode_kernel
.p2align 8
.type adaLN_cond__mha_block_cached__geglu_ffn__decode_kernel,@function
adaLN_cond__mha_block_cached__geglu_ffn__decode_kernel:
s_cmp_ge_u32 s2, 256
s_cbranch_scc1 L_end
s_load_dwordx16 s[48:63], s[0:1], 0
s_load_dwordx8 s[64:71], s[0:1], 64
s_load_dwordx4 s[72:75], s[0:1], 96
v_lshrrev_b32 v1, 6, v0
v_lshlrev_b32 v2, 2, v0
v_mov_b32 v3, 0
v_readfirstlane_b32 s31, v1
ds_write_b32 v2, v3
s_lshr_b32 s32, s2, 3
s_and_b32 s33, s2, 7
s_add_u32 s35, s32, s33
s_and_b32 s35, s35, 7
s_mov_b32 s76, 0xcccccccc
s_mov_b32 s77, 0xcccccccc
s_mov_b32 s78, 0xffff0000
s_mov_b32 s79, 100000
s_mov_b32 s27, 0x3fb8aa3b
v_and_b32 v1, 63, v0
s_waitcnt lgkmcnt(0)
s_mov_b32 s16, s74
s_mov_b32 s17, s75
s_mov_b32 s18, 4194304
s_mov_b32 s19, 0x20000
s_cmp_lt_u32 s31, 4
s_cbranch_scc1 L_stream
s_load_dword s46, s[74:75], 36864
s_sub_u32 s31, s31, 4
v_and_b32 v0, 255, v0
v_lshrrev_b32 v2, 1, v0
v_lshlrev_b32 v9, 3, v2
v_lshlrev_b32 v2, 4, v2
v_and_b32 v11, 7, v0
v_lshlrev_b32 v11, 4, v11
v_lshlrev_b32 v5, 4, v1
s_lshl_b32 s34, s32, 1
s_and_b32 s3, s35, 1
s_add_u32 s34, s34, s3
s_cmp_lt_u32 s35, 2
s_cbranch_scc1 L_rq
s_cmp_lt_u32 s35, 4
s_cbranch_scc1 L_r0
s_mov_b32 s34, s32
s_cmp_eq_u32 s35, 4
s_cbranch_scc1 L_rm
s_cmp_eq_u32 s35, 6
s_cselect_b32 s3, 28, 16
s_cmp_lt_u32 s32, s3
s_cselect_b32 s3, s35, 8
s_cmp_eq_u32 s35, 5
s_mov_b32 s35, s3
s_cbranch_scc0 L_r0
s_add_u32 s34, s32, 16
s_cmp_eq_u32 s35, 8
s_mov_b32 s35, 8
s_cbranch_scc0 L_r0
L_rm:
s_lshl_b32 s36, s34, 7
s_mov_b32 s8, s66
s_mov_b32 s9, s67
s_mov_b32 s10, 1024
s_mov_b32 s11, 0x20000
buffer_load_dwordx2 v[56:57], v9, s[8:11], 0 offen
s_mov_b32 s4, s68
s_mov_b32 s5, s69
s_mov_b32 s6, 3145728
s_mov_b32 s7, 0x20000
v_lshrrev_b32 v4, 3, v0
v_mul_u32_u24 v4, 98304, v4
v_add_u32 v4, v11, v4
s_add_u32 s3, s36, 0
buffer_load_dwordx4 v[64:67], v4, s[4:7], s3 offen nt
s_add_u32 s3, s36, 6144
buffer_load_dwordx4 v[68:71], v4, s[4:7], s3 offen nt
s_add_u32 s3, s36, 12288
buffer_load_dwordx4 v[72:75], v4, s[4:7], s3 offen nt
s_add_u32 s3, s36, 18432
buffer_load_dwordx4 v[76:79], v4, s[4:7], s3 offen nt
s_add_u32 s3, s36, 24576
buffer_load_dwordx4 v[80:83], v4, s[4:7], s3 offen nt
s_add_u32 s3, s36, 30720
buffer_load_dwordx4 v[84:87], v4, s[4:7], s3 offen nt
s_add_u32 s3, s36, 36864
buffer_load_dwordx4 v[88:91], v4, s[4:7], s3 offen nt
s_add_u32 s3, s36, 43008
buffer_load_dwordx4 v[92:95], v4, s[4:7], s3 offen nt
s_add_u32 s3, s36, 49152
buffer_load_dwordx4 v[96:99], v4, s[4:7], s3 offen nt
s_add_u32 s3, s36, 55296
buffer_load_dwordx4 v[100:103], v4, s[4:7], s3 offen nt
s_add_u32 s3, s36, 61440
buffer_load_dwordx4 v[104:107], v4, s[4:7], s3 offen nt
s_add_u32 s3, s36, 67584
buffer_load_dwordx4 v[108:111], v4, s[4:7], s3 offen nt
s_add_u32 s3, s36, 73728
buffer_load_dwordx4 v[112:115], v4, s[4:7], s3 offen nt
s_add_u32 s3, s36, 79872
buffer_load_dwordx4 v[116:119], v4, s[4:7], s3 offen nt
s_add_u32 s3, s36, 86016
buffer_load_dwordx4 v[120:123], v4, s[4:7], s3 offen nt
s_add_u32 s3, s36, 92160
buffer_load_dwordx4 v[124:127], v4, s[4:7], s3 offen nt
s_barrier
v_and_b32 v3, 1, v0
v_lshrrev_b32 v6, 3, v1
v_lshrrev_b32 v7, 1, v11
v_add_u32 v6, v6, v7
v_lshlrev_b32 v7, 4, v6
v_lshlrev_b32 v6, 2, v6
s_lshl_b32 s3, s31, 8
v_add_u32 v6, s3, v6
s_lshl_b32 s3, s31, 2
v_add_u32 v7, s3, v7
s_mov_b32 s28, 0x05040100
s_mov_b32 s29, 0x07060302
v_and_b32 v130, 0xff, v5
v_lshrrev_b32 v131, 4, v1
v_mul_u32_u24 v131, 20736, v131
v_add_u32 v131, v131, v130
s_and_b32 s25, s34, 0
s_mul_i32 s25, s25, 20736
s_add_u32 s25, s25, 0
s_waitcnt lgkmcnt(0)
s_mul_i32 s46, s46, 0x9e3779b1
s_add_u32 s46, s46, 0x7f4a7c15
s_waitcnt vmcnt(16)
v_lshlrev_b32 v12, 16, v56
v_and_b32 v13, s78, v56
v_lshlrev_b32 v14, 16, v57
v_and_b32 v15, s78, v57
v_mul_f32 v40, s27, v12
v_mul_f32 v41, s27, v13
v_mul_f32 v42, s27, v14
v_mul_f32 v43, s27, v15
v_exp_f32 v40, -v40
v_exp_f32 v41, -v41
v_exp_f32 v42, -v42
v_exp_f32 v43, -v43
v_add_f32 v40, 1.0, v40
v_add_f32 v41, 1.0, v41
v_add_f32 v42, 1.0, v42
v_add_f32 v43, 1.0, v43
v_rcp_f32 v44, v40
v_rcp_f32 v45, v41
v_rcp_f32 v46, v42
v_rcp_f32 v47, v43
v_min_f32 v40, 0x7f7fffff, v40
v_min_f32 v41, 0x7f7fffff, v41
v_min_f32 v42, 0x7f7fffff, v42
v_min_f32 v43, 0x7f7fffff, v43
v_mul_f32 v16, v12, v44
v_mul_f32 v17, v13, v45
v_mul_f32 v18, v14, v46
v_mul_f32 v19, v15, v47
v_fma_f32 v12, -v16, v40, v12
v_fma_f32 v13, -v17, v41, v13
v_fma_f32 v14, -v18, v42, v14
v_fma_f32 v15, -v19, v43, v15
v_fma_f32 v12, v12, v44, v16
v_fma_f32 v13, v13, v45, v17
v_fma_f32 v14, v14, v46, v18
v_fma_f32 v15, v15, v47, v19
s_waitcnt vmcnt(0)
v_perm_b32 v60, v68, v64, s28
v_perm_b32 v64, v68, v64, s29
v_perm_b32 v61, v69, v65, s28
v_perm_b32 v65, v69, v65, s29
v_perm_b32 v62, v70, v66, s28
v_perm_b32 v66, v70, v66, s29
v_perm_b32 v63, v71, v67, s28
v_perm_b32 v67, v71, v67, s29
v_perm_b32 v68, v76, v72, s28
v_perm_b32 v72, v76, v72, s29
v_perm_b32 v69, v77, v73, s28
v_perm_b32 v73, v77, v73, s29
v_perm_b32 v70, v78, v74, s28
v_perm_b32 v74, v78, v74, s29
v_perm_b32 v71, v79, v75, s28
v_perm_b32 v75, v79, v75, s29
v_perm_b32 v76, v84, v80, s28
v_perm_b32 v80, v84, v80, s29
v_perm_b32 v77, v85, v81, s28
v_perm_b32 v81, v85, v81, s29
v_perm_b32 v78, v86, v82, s28
v_perm_b32 v82, v86, v82, s29
v_perm_b32 v79, v87, v83, s28
v_perm_b32 v83, v87, v83, s29
v_perm_b32 v84, v92, v88, s28
v_perm_b32 v88, v92, v88, s29
v_perm_b32 v85, v93, v89, s28
v_perm_b32 v89, v93, v89, s29
v_perm_b32 v86, v94, v90, s28
v_perm_b32 v90, v94, v90, s29
v_perm_b32 v87, v95, v91, s28
v_perm_b32 v91, v95, v91, s29
v_perm_b32 v92, v100, v96, s28
v_perm_b32 v96, v100, v96, s29
v_perm_b32 v93, v101, v97, s28
v_perm_b32 v97, v101, v97, s29
v_perm_b32 v94, v102, v98, s28
v_perm_b32 v98, v102, v98, s29
v_perm_b32 v95, v103, v99, s28
v_perm_b32 v99, v103, v99, s29
v_perm_b32 v100, v108, v104, s28
v_perm_b32 v104, v108, v104, s29
v_perm_b32 v101, v109, v105, s28
v_perm_b32 v105, v109, v105, s29
v_perm_b32 v102, v110, v106, s28
v_perm_b32 v106, v110, v106, s29
v_perm_b32 v103, v111, v107, s28
v_perm_b32 v107, v111, v107, s29
v_perm_b32 v108, v116, v112, s28
v_perm_b32 v112, v116, v112, s29
v_perm_b32 v109, v117, v113, s28
v_perm_b32 v113, v117, v113, s29
v_perm_b32 v110, v118, v114, s28
v_perm_b32 v114, v118, v114, s29
v_perm_b32 v111, v119, v115, s28
v_perm_b32 v115, v119, v115, s29
v_perm_b32 v116, v124, v120, s28
v_perm_b32 v120, v124, v120, s29
v_perm_b32 v117, v125, v121, s28
v_perm_b32 v121, v125, v121, s29
v_perm_b32 v118, v126, v122, s28
v_perm_b32 v122, v126, v122, s29
v_perm_b32 v119, v127, v123, s28
v_perm_b32 v123, v127, v123, s29
v_cvt_pk_bf16_f32 v12, v12, v13
v_cvt_pk_bf16_f32 v13, v14, v15
s_nop 0
v_mov_b32_dpp v16, v12 row_newbcast:0 row_mask:0xf bank_mask:0x3
v_mov_b32_dpp v17, v13 row_newbcast:0 row_mask:0xf bank_mask:0x3
v_mov_b32_dpp v18, v12 row_newbcast:2 row_mask:0xf bank_mask:0x3
v_mov_b32_dpp v19, v13 row_newbcast:2 row_mask:0xf bank_mask:0x3
v_mov_b32_dpp v20, v12 row_newbcast:4 row_mask:0xf bank_mask:0x3
v_mov_b32_dpp v21, v13 row_newbcast:4 row_mask:0xf bank_mask:0x3
v_mov_b32_dpp v22, v12 row_newbcast:6 row_mask:0xf bank_mask:0x3
v_mov_b32_dpp v23, v13 row_newbcast:6 row_mask:0xf bank_mask:0x3
v_mov_b32_dpp v16, v12 row_newbcast:8 row_mask:0xf bank_mask:0xc
v_mov_b32_dpp v17, v13 row_newbcast:8 row_mask:0xf bank_mask:0xc
v_mov_b32_dpp v18, v12 row_newbcast:10 row_mask:0xf bank_mask:0xc
v_mov_b32_dpp v19, v13 row_newbcast:10 row_mask:0xf bank_mask:0xc
v_mov_b32_dpp v20, v12 row_newbcast:12 row_mask:0xf bank_mask:0xc
v_mov_b32_dpp v21, v13 row_newbcast:12 row_mask:0xf bank_mask:0xc
v_mov_b32_dpp v22, v12 row_newbcast:14 row_mask:0xf bank_mask:0xc
v_mov_b32_dpp v23, v13 row_newbcast:14 row_mask:0xf bank_mask:0xc
v_dot2_f32_bf16 v24, v60, v16, 0
v_dot2_f32_bf16 v25, v64, v16, 0
v_dot2_f32_bf16 v26, v61, v16, 0
v_dot2_f32_bf16 v27, v65, v16, 0
v_dot2_f32_bf16 v28, v62, v16, 0
v_dot2_f32_bf16 v29, v66, v16, 0
v_dot2_f32_bf16 v30, v63, v16, 0
v_dot2_f32_bf16 v31, v67, v16, 0
v_dot2_f32_bf16 v24, v68, v17, v24
v_dot2_f32_bf16 v25, v72, v17, v25
v_dot2_f32_bf16 v26, v69, v17, v26
v_dot2_f32_bf16 v27, v73, v17, v27
v_dot2_f32_bf16 v28, v70, v17, v28
v_dot2_f32_bf16 v29, v74, v17, v29
v_dot2_f32_bf16 v30, v71, v17, v30
v_dot2_f32_bf16 v31, v75, v17, v31
v_dot2_f32_bf16 v24, v76, v18, v24
v_dot2_f32_bf16 v25, v80, v18, v25
v_dot2_f32_bf16 v26, v77, v18, v26
v_dot2_f32_bf16 v27, v81, v18, v27
v_dot2_f32_bf16 v28, v78, v18, v28
v_dot2_f32_bf16 v29, v82, v18, v29
v_dot2_f32_bf16 v30, v79, v18, v30
v_dot2_f32_bf16 v31, v83, v18, v31
v_dot2_f32_bf16 v24, v84, v19, v24
v_dot2_f32_bf16 v25, v88, v19, v25
v_dot2_f32_bf16 v26, v85, v19, v26
v_dot2_f32_bf16 v27, v89, v19, v27
v_dot2_f32_bf16 v28, v86, v19, v28
v_dot2_f32_bf16 v29, v90, v19, v29
v_dot2_f32_bf16 v30, v87, v19, v30
v_dot2_f32_bf16 v31, v91, v19, v31
v_dot2_f32_bf16 v24, v92, v20, v24
v_dot2_f32_bf16 v25, v96, v20, v25
v_dot2_f32_bf16 v26, v93, v20, v26
v_dot2_f32_bf16 v27, v97, v20, v27
v_dot2_f32_bf16 v28, v94, v20, v28
v_dot2_f32_bf16 v29, v98, v20, v29
v_dot2_f32_bf16 v30, v95, v20, v30
v_dot2_f32_bf16 v31, v99, v20, v31
v_dot2_f32_bf16 v24, v100, v21, v24
v_dot2_f32_bf16 v25, v104, v21, v25
v_dot2_f32_bf16 v26, v101, v21, v26
v_dot2_f32_bf16 v27, v105, v21, v27
v_dot2_f32_bf16 v28, v102, v21, v28
v_dot2_f32_bf16 v29, v106, v21, v29
v_dot2_f32_bf16 v30, v103, v21, v30
v_dot2_f32_bf16 v31, v107, v21, v31
v_dot2_f32_bf16 v24, v108, v22, v24
v_dot2_f32_bf16 v25, v112, v22, v25
v_dot2_f32_bf16 v26, v109, v22, v26
v_dot2_f32_bf16 v27, v113, v22, v27
v_dot2_f32_bf16 v28, v110, v22, v28
v_dot2_f32_bf16 v29, v114, v22, v29
v_dot2_f32_bf16 v30, v111, v22, v30
v_dot2_f32_bf16 v31, v115, v22, v31
v_dot2_f32_bf16 v24, v116, v23, v24
v_dot2_f32_bf16 v25, v120, v23, v25
v_dot2_f32_bf16 v26, v117, v23, v26
v_dot2_f32_bf16 v27, v121, v23, v27
v_dot2_f32_bf16 v28, v118, v23, v28
v_dot2_f32_bf16 v29, v122, v23, v29
v_dot2_f32_bf16 v30, v119, v23, v30
v_dot2_f32_bf16 v31, v123, v23, v31
v_add_f32_dpp v24, v24, v24 row_ror:8 row_mask:0xf bank_mask:0x3
v_add_f32_dpp v26, v26, v26 row_ror:8 row_mask:0xf bank_mask:0x3
v_add_f32_dpp v28, v28, v28 row_ror:8 row_mask:0xf bank_mask:0x3
v_add_f32_dpp v30, v30, v30 row_ror:8 row_mask:0xf bank_mask:0x3
v_add_f32_dpp v24, v25, v25 row_ror:8 row_mask:0xf bank_mask:0xc
v_add_f32_dpp v26, v27, v27 row_ror:8 row_mask:0xf bank_mask:0xc
v_add_f32_dpp v28, v29, v29 row_ror:8 row_mask:0xf bank_mask:0xc
v_add_f32_dpp v30, v31, v31 row_ror:8 row_mask:0xf bank_mask:0xc
v_permlane16_swap_b32 v24, v26
s_nop 0
v_permlane16_swap_b32 v28, v30
v_add_f32 v24, v24, v26
v_add_f32 v28, v28, v30
s_nop 1
v_permlane32_swap_b32 v24, v28
v_add_f32 v24, v24, v28
ds_write_b32 v6, v24 offset:1024
s_mov_b64 exec, 1
v_mov_b32 v56, 0
v_mov_b32 v57, 1
ds_add_u32 v56, v57 offset:0
s_mov_b64 exec, -1
s_cmp_lg_u32 s31, 0
s_cbranch_scc1 L_h3
v_mov_b32 v56, 0
L_wf1:
ds_read_b32 v57, v56 offset:0
s_waitcnt lgkmcnt(0)
v_readfirstlane_b32 s3, v57
s_cmp_ge_u32 s3, 4
s_cbranch_scc1 L_wd2
s_sub_u32 s79, s79, 1
s_cbranch_scc0 L_wf1
s_mov_b32 s79, 0
L_wd2:
s_mov_b64 exec, 0xffff
ds_read_b128 v[24:27], v130 offset:1024
ds_read_b128 v[28:31], v130 offset:1280
ds_read_b128 v[32:35], v130 offset:1536
ds_read_b128 v[36:39], v130 offset:1792
s_waitcnt lgkmcnt(0)
v_add_f32 v24, v24, v28
v_add_f32 v32, v32, v36
v_add_f32 v25, v25, v29
v_add_f32 v33, v33, v37
v_add_f32 v26, v26, v30
v_add_f32 v34, v34, v38
v_add_f32 v27, v27, v31
v_add_f32 v35, v35, v39
v_add_f32 v24, v24, v32
v_add_f32 v25, v25, v33
v_add_f32 v26, v26, v34
v_add_f32 v27, v27, v35
v_cvt_pk_bf16_f32 v24, v24, v25
v_cvt_pk_bf16_f32 v26, v26, v27
v_mov_b32 v25, s46
v_mov_b32 v27, s46
s_lshl_b32 s3, s34, 8
s_add_u32 s3, s3, 0
buffer_store_dwordx4 v[24:27], v131, s[16:19], s3 offen sc1
s_mov_b64 exec, -1
s_branch L_h1
L_rq:
s_lshl_b32 s36, s34, 7
s_mov_b32 s8, s48
s_mov_b32 s9, s49
s_mov_b32 s10, 1024
s_mov_b32 s11, 0x20000
buffer_load_dwordx2 v[56:57], v9, s[8:11], 0 offen
buffer_load_dwordx4 v[16:19], v5, s[8:11], 0 offen
s_mov_b32 s4, s54
s_mov_b32 s5, s55
s_mov_b32 s6, 4194304
s_mov_b32 s7, 0x20000
v_lshrrev_b32 v4, 3, v0
v_mul_u32_u24 v4, 131072, v4
v_add_u32 v4, v11, v4
s_add_u32 s3, s36, 0
buffer_load_dwordx4 v[64:67], v4, s[4:7], s3 offen nt
s_add_u32 s3, s36, 8192
buffer_load_dwordx4 v[68:71], v4, s[4:7], s3 offen nt
s_add_u32 s3, s36, 16384
buffer_load_dwordx4 v[72:75], v4, s[4:7], s3 offen nt
s_add_u32 s3, s36, 24576
buffer_load_dwordx4 v[76:79], v4, s[4:7], s3 offen nt
s_add_u32 s3, s36, 32768
buffer_load_dwordx4 v[80:83], v4, s[4:7], s3 offen nt
s_add_u32 s3, s36, 40960
buffer_load_dwordx4 v[84:87], v4, s[4:7], s3 offen nt
s_add_u32 s3, s36, 49152
buffer_load_dwordx4 v[88:91], v4, s[4:7], s3 offen nt
s_add_u32 s3, s36, 57344
buffer_load_dwordx4 v[92:95], v4, s[4:7], s3 offen nt
s_add_u32 s3, s36, 65536
buffer_load_dwordx4 v[96:99], v4, s[4:7], s3 offen nt
s_add_u32 s3, s36, 73728
buffer_load_dwordx4 v[100:103], v4, s[4:7], s3 offen nt
s_add_u32 s3, s36, 81920
buffer_load_dwordx4 v[104:107], v4, s[4:7], s3 offen nt
s_add_u32 s3, s36, 90112
buffer_load_dwordx4 v[108:111], v4, s[4:7], s3 offen nt
s_add_u32 s3, s36, 98304
buffer_load_dwordx4 v[112:115], v4, s[4:7], s3 offen nt
s_add_u32 s3, s36, 106496
buffer_load_dwordx4 v[116:119], v4, s[4:7], s3 offen nt
s_add_u32 s3, s36, 114688
buffer_load_dwordx4 v[120:123], v4, s[4:7], s3 offen nt
s_add_u32 s3, s36, 122880
buffer_load_dwordx4 v[124:127], v4, s[4:7], s3 offen nt
s_barrier
v_and_b32 v3, 1, v0
v_lshrrev_b32 v6, 3, v1
v_lshrrev_b32 v7, 1, v11
v_add_u32 v6, v6, v7
v_lshlrev_b32 v7, 4, v6
v_lshlrev_b32 v6, 2, v6
s_lshl_b32 s3, s31, 8
v_add_u32 v6, s3, v6
s_lshl_b32 s3, s31, 2
v_add_u32 v7, s3, v7
s_mov_b32 s28, 0x05040100
s_mov_b32 s29, 0x07060302
v_and_b32 v130, 0xff, v5
v_lshrrev_b32 v131, 4, v1
v_mul_u32_u24 v131, 20736, v131
v_add_u32 v131, v131, v130
s_and_b32 s25, s34, 0
s_mul_i32 s25, s25, 20736
s_add_u32 s25, s25, 0
s_waitcnt lgkmcnt(0)
s_mul_i32 s46, s46, 0x9e3779b1
s_add_u32 s46, s46, 0x7f4a7c15
s_waitcnt vmcnt(16)
v_lshlrev_b32 v40, 16, v56
v_and_b32 v41, s78, v56
v_lshlrev_b32 v42, 16, v57
v_and_b32 v43, s78, v57
v_lshlrev_b32 v24, 16, v16
v_and_b32 v25, s78, v16
v_lshlrev_b32 v26, 16, v17
v_and_b32 v27, s78, v17
v_lshlrev_b32 v28, 16, v18
v_and_b32 v29, s78, v18
v_lshlrev_b32 v30, 16, v19
v_and_b32 v31, s78, v19
v_add_f32 v56, v24, v25
v_add_f32 v56, v56, v26
v_add_f32 v56, v56, v27
v_add_f32 v56, v56, v28
v_add_f32 v56, v56, v29
v_add_f32 v56, v56, v30
v_add_f32 v56, v56, v31
s_nop 1
v_add_f32_dpp v56, v56, v56 row_ror:8 row_mask:0xf bank_mask:0xf
s_nop 1
v_add_f32_dpp v56, v56, v56 row_ror:4 row_mask:0xf bank_mask:0xf
s_nop 1
v_add_f32_dpp v56, v56, v56 row_ror:2 row_mask:0xf bank_mask:0xf
s_nop 1
v_add_f32_dpp v56, v56, v56 row_ror:1 row_mask:0xf bank_mask:0xf
v_mov_b32 v57, v56
s_nop 1
v_permlane16_swap_b32 v56, v57
v_add_f32 v56, v56, v57
v_mov_b32 v57, v56
s_nop 1
v_permlane32_swap_b32 v56, v57
v_add_f32 v56, v56, v57
v_mul_f32 v56, 0x3b000000, v56
v_sub_f32 v24, v24, v56
v_sub_f32 v25, v25, v56
v_sub_f32 v26, v26, v56
v_sub_f32 v27, v27, v56
v_sub_f32 v28, v28, v56
v_sub_f32 v29, v29, v56
v_sub_f32 v30, v30, v56
v_sub_f32 v31, v31, v56
v_mul_f32 v57, v24, v24
v_fmac_f32 v57, v25, v25
v_fmac_f32 v57, v26, v26
v_fmac_f32 v57, v27, v27
v_fmac_f32 v57, v28, v28
v_fmac_f32 v57, v29, v29
v_fmac_f32 v57, v30, v30
v_fmac_f32 v57, v31, v31
s_nop 1
v_add_f32_dpp v57, v57, v57 row_ror:8 row_mask:0xf bank_mask:0xf
s_nop 1
v_add_f32_dpp v57, v57, v57 row_ror:4 row_mask:0xf bank_mask:0xf
s_nop 1
v_add_f32_dpp v57, v57, v57 row_ror:2 row_mask:0xf bank_mask:0xf
s_nop 1
v_add_f32_dpp v57, v57, v57 row_ror:1 row_mask:0xf bank_mask:0xf
v_mov_b32 v58, v57
s_nop 1
v_permlane16_swap_b32 v57, v58
v_add_f32 v57, v57, v58
v_mov_b32 v58, v57
s_nop 1
v_permlane32_swap_b32 v57, v58
v_add_f32 v57, v57, v58
v_mul_f32 v57, 0x3b000000, v57
v_cvt_pk_bf16_f32 v56, v56, v56
v_cvt_pk_bf16_f32 v57, v57, v57
v_lshlrev_b32 v56, 16, v56
v_lshlrev_b32 v57, 16, v57
v_add_f32 v57, 0x3727c5ac, v57
v_cvt_pk_bf16_f32 v57, v57, v57
v_lshlrev_b32 v57, 16, v57
v_sqrt_f32 v57, v57
s_nop 0
v_cvt_pk_bf16_f32 v57, v57, v57
v_lshlrev_b32 v57, 16, v57
v_rcp_f32 v58, v57
v_sub_f32 v12, v40, v56
v_sub_f32 v13, v41, v56
v_sub_f32 v14, v42, v56
v_sub_f32 v15, v43, v56
v_cvt_pk_bf16_f32 v12, v12, v12
v_cvt_pk_bf16_f32 v13, v13, v13
v_cvt_pk_bf16_f32 v14, v14, v14
v_cvt_pk_bf16_f32 v15, v15, v15
v_lshlrev_b32 v12, 16, v12
v_lshlrev_b32 v13, 16, v13
v_lshlrev_b32 v14, 16, v14
v_lshlrev_b32 v15, 16, v15
v_mul_f32 v16, v12, v58
v_mul_f32 v17, v13, v58
v_mul_f32 v18, v14, v58
v_mul_f32 v19, v15, v58
v_fma_f32 v12, -v16, v57, v12
v_fma_f32 v13, -v17, v57, v13
v_fma_f32 v14, -v18, v57, v14
v_fma_f32 v15, -v19, v57, v15
v_fma_f32 v12, v12, v58, v16
v_fma_f32 v13, v13, v58, v17
v_fma_f32 v14, v14, v58, v18
v_fma_f32 v15, v15, v58, v19
v_cvt_pk_bf16_f32 v12, v12, v12
v_cvt_pk_bf16_f32 v13, v13, v13
v_cvt_pk_bf16_f32 v14, v14, v14
v_cvt_pk_bf16_f32 v15, v15, v15
v_lshlrev_b32 v12, 16, v12
v_lshlrev_b32 v13, 16, v13
v_lshlrev_b32 v14, 16, v14
v_lshlrev_b32 v15, 16, v15
s_waitcnt vmcnt(0)
v_perm_b32 v60, v68, v64, s28
v_perm_b32 v64, v68, v64, s29
v_perm_b32 v61, v69, v65, s28
v_perm_b32 v65, v69, v65, s29
v_perm_b32 v62, v70, v66, s28
v_perm_b32 v66, v70, v66, s29
v_perm_b32 v63, v71, v67, s28
v_perm_b32 v67, v71, v67, s29
v_perm_b32 v68, v76, v72, s28
v_perm_b32 v72, v76, v72, s29
v_perm_b32 v69, v77, v73, s28
v_perm_b32 v73, v77, v73, s29
v_perm_b32 v70, v78, v74, s28
v_perm_b32 v74, v78, v74, s29
v_perm_b32 v71, v79, v75, s28
v_perm_b32 v75, v79, v75, s29
v_perm_b32 v76, v84, v80, s28
v_perm_b32 v80, v84, v80, s29
v_perm_b32 v77, v85, v81, s28
v_perm_b32 v81, v85, v81, s29
v_perm_b32 v78, v86, v82, s28
v_perm_b32 v82, v86, v82, s29
v_perm_b32 v79, v87, v83, s28
v_perm_b32 v83, v87, v83, s29
v_perm_b32 v84, v92, v88, s28
v_perm_b32 v88, v92, v88, s29
v_perm_b32 v85, v93, v89, s28
v_perm_b32 v89, v93, v89, s29
v_perm_b32 v86, v94, v90, s28
v_perm_b32 v90, v94, v90, s29
v_perm_b32 v87, v95, v91, s28
v_perm_b32 v91, v95, v91, s29
v_perm_b32 v92, v100, v96, s28
v_perm_b32 v96, v100, v96, s29
v_perm_b32 v93, v101, v97, s28
v_perm_b32 v97, v101, v97, s29
v_perm_b32 v94, v102, v98, s28
v_perm_b32 v98, v102, v98, s29
v_perm_b32 v95, v103, v99, s28
v_perm_b32 v99, v103, v99, s29
v_perm_b32 v100, v108, v104, s28
v_perm_b32 v104, v108, v104, s29
v_perm_b32 v101, v109, v105, s28
v_perm_b32 v105, v109, v105, s29
v_perm_b32 v102, v110, v106, s28
v_perm_b32 v106, v110, v106, s29
v_perm_b32 v103, v111, v107, s28
v_perm_b32 v107, v111, v107, s29
v_perm_b32 v108, v116, v112, s28
v_perm_b32 v112, v116, v112, s29
v_perm_b32 v109, v117, v113, s28
v_perm_b32 v113, v117, v113, s29
v_perm_b32 v110, v118, v114, s28
v_perm_b32 v114, v118, v114, s29
v_perm_b32 v111, v119, v115, s28
v_perm_b32 v115, v119, v115, s29
v_perm_b32 v116, v124, v120, s28
v_perm_b32 v120, v124, v120, s29
v_perm_b32 v117, v125, v121, s28
v_perm_b32 v121, v125, v121, s29
v_perm_b32 v118, v126, v122, s28
v_perm_b32 v122, v126, v122, s29
v_perm_b32 v119, v127, v123, s28
v_perm_b32 v123, v127, v123, s29
L_p3:
buffer_load_dwordx4 v[48:51], v2, s[16:19], s25 offen offset:0 sc1
buffer_load_dwordx4 v[52:55], v2, s[16:19], s25 offen offset:2048 sc1
s_waitcnt vmcnt(0)
v_xor_b32 v49, s46, v49
v_xor_b32 v51, s46, v51
v_xor_b32 v53, s46, v53
v_xor_b32 v55, s46, v55
v_or_b32 v56, v49, v51
v_or3_b32 v56, v53, v55, v56
v_cmp_ne_u32 vcc, 0, v56
s_cbranch_vccz L_pd4
s_sub_u32 s79, s79, 1
s_cbranch_scc0 L_p3
s_mov_b32 s79, 0
L_pd4:
v_and_b32 v49, s78, v48
v_and_b32 v51, s78, v50
v_and_b32 v53, s78, v52
v_and_b32 v55, s78, v54
v_lshlrev_b32 v48, 16, v48
v_lshlrev_b32 v50, 16, v50
v_lshlrev_b32 v52, 16, v52
v_lshlrev_b32 v54, 16, v54
v_add_f32 v52, 1.0, v52
v_add_f32 v53, 1.0, v53
v_add_f32 v54, 1.0, v54
v_add_f32 v55, 1.0, v55
v_cvt_pk_bf16_f32 v52, v52, v52
v_cvt_pk_bf16_f32 v53, v53, v53
v_cvt_pk_bf16_f32 v54, v54, v54
v_cvt_pk_bf16_f32 v55, v55, v55
v_lshlrev_b32 v52, 16, v52
v_lshlrev_b32 v53, 16, v53
v_lshlrev_b32 v54, 16, v54
v_lshlrev_b32 v55, 16, v55
v_mul_f32 v12, v12, v52
v_mul_f32 v13, v13, v53
v_mul_f32 v14, v14, v54
v_mul_f32 v15, v15, v55
v_cvt_pk_bf16_f32 v12, v12, v12
v_cvt_pk_bf16_f32 v13, v13, v13
v_cvt_pk_bf16_f32 v14, v14, v14
v_cvt_pk_bf16_f32 v15, v15, v15
v_lshlrev_b32 v12, 16, v12
v_lshlrev_b32 v13, 16, v13
v_lshlrev_b32 v14, 16, v14
v_lshlrev_b32 v15, 16, v15
v_add_f32 v12, v12, v48
v_add_f32 v13, v13, v49
v_add_f32 v14, v14, v50
v_add_f32 v15, v15, v51
v_cvt_pk_bf16_f32 v12, v12, v13
v_cvt_pk_bf16_f32 v13, v14, v15
s_nop 0
v_mov_b32_dpp v16, v12 row_newbcast:0 row_mask:0xf bank_mask:0x3
v_mov_b32_dpp v17, v13 row_newbcast:0 row_mask:0xf bank_mask:0x3
v_mov_b32_dpp v18, v12 row_newbcast:2 row_mask:0xf bank_mask:0x3
v_mov_b32_dpp v19, v13 row_newbcast:2 row_mask:0xf bank_mask:0x3
v_mov_b32_dpp v20, v12 row_newbcast:4 row_mask:0xf bank_mask:0x3
v_mov_b32_dpp v21, v13 row_newbcast:4 row_mask:0xf bank_mask:0x3
v_mov_b32_dpp v22, v12 row_newbcast:6 row_mask:0xf bank_mask:0x3
v_mov_b32_dpp v23, v13 row_newbcast:6 row_mask:0xf bank_mask:0x3
v_mov_b32_dpp v16, v12 row_newbcast:8 row_mask:0xf bank_mask:0xc
v_mov_b32_dpp v17, v13 row_newbcast:8 row_mask:0xf bank_mask:0xc
v_mov_b32_dpp v18, v12 row_newbcast:10 row_mask:0xf bank_mask:0xc
v_mov_b32_dpp v19, v13 row_newbcast:10 row_mask:0xf bank_mask:0xc
v_mov_b32_dpp v20, v12 row_newbcast:12 row_mask:0xf bank_mask:0xc
v_mov_b32_dpp v21, v13 row_newbcast:12 row_mask:0xf bank_mask:0xc
v_mov_b32_dpp v22, v12 row_newbcast:14 row_mask:0xf bank_mask:0xc
v_mov_b32_dpp v23, v13 row_newbcast:14 row_mask:0xf bank_mask:0xc
v_dot2_f32_bf16 v24, v60, v16, 0
v_dot2_f32_bf16 v25, v64, v16, 0
v_dot2_f32_bf16 v26, v61, v16, 0
v_dot2_f32_bf16 v27, v65, v16, 0
v_dot2_f32_bf16 v28, v62, v16, 0
v_dot2_f32_bf16 v29, v66, v16, 0
v_dot2_f32_bf16 v30, v63, v16, 0
v_dot2_f32_bf16 v31, v67, v16, 0
v_dot2_f32_bf16 v24, v68, v17, v24
v_dot2_f32_bf16 v25, v72, v17, v25
v_dot2_f32_bf16 v26, v69, v17, v26
v_dot2_f32_bf16 v27, v73, v17, v27
v_dot2_f32_bf16 v28, v70, v17, v28
v_dot2_f32_bf16 v29, v74, v17, v29
v_dot2_f32_bf16 v30, v71, v17, v30
v_dot2_f32_bf16 v31, v75, v17, v31
v_dot2_f32_bf16 v24, v76, v18, v24
v_dot2_f32_bf16 v25, v80, v18, v25
v_dot2_f32_bf16 v26, v77, v18, v26
v_dot2_f32_bf16 v27, v81, v18, v27
v_dot2_f32_bf16 v28, v78, v18, v28
v_dot2_f32_bf16 v29, v82, v18, v29
v_dot2_f32_bf16 v30, v79, v18, v30
v_dot2_f32_bf16 v31, v83, v18, v31
v_dot2_f32_bf16 v24, v84, v19, v24
v_dot2_f32_bf16 v25, v88, v19, v25
v_dot2_f32_bf16 v26, v85, v19, v26
v_dot2_f32_bf16 v27, v89, v19, v27
v_dot2_f32_bf16 v28, v86, v19, v28
v_dot2_f32_bf16 v29, v90, v19, v29
v_dot2_f32_bf16 v30, v87, v19, v30
v_dot2_f32_bf16 v31, v91, v19, v31
v_dot2_f32_bf16 v24, v92, v20, v24
v_dot2_f32_bf16 v25, v96, v20, v25
v_dot2_f32_bf16 v26, v93, v20, v26
v_dot2_f32_bf16 v27, v97, v20, v27
v_dot2_f32_bf16 v28, v94, v20, v28
v_dot2_f32_bf16 v29, v98, v20, v29
v_dot2_f32_bf16 v30, v95, v20, v30
v_dot2_f32_bf16 v31, v99, v20, v31
v_dot2_f32_bf16 v24, v100, v21, v24
v_dot2_f32_bf16 v25, v104, v21, v25
v_dot2_f32_bf16 v26, v101, v21, v26
v_dot2_f32_bf16 v27, v105, v21, v27
v_dot2_f32_bf16 v28, v102, v21, v28
v_dot2_f32_bf16 v29, v106, v21, v29
v_dot2_f32_bf16 v30, v103, v21, v30
v_dot2_f32_bf16 v31, v107, v21, v31
v_dot2_f32_bf16 v24, v108, v22, v24
v_dot2_f32_bf16 v25, v112, v22, v25
v_dot2_f32_bf16 v26, v109, v22, v26
v_dot2_f32_bf16 v27, v113, v22, v27
v_dot2_f32_bf16 v28, v110, v22, v28
v_dot2_f32_bf16 v29, v114, v22, v29
v_dot2_f32_bf16 v30, v111, v22, v30
v_dot2_f32_bf16 v31, v115, v22, v31
v_dot2_f32_bf16 v24, v116, v23, v24
v_dot2_f32_bf16 v25, v120, v23, v25
v_dot2_f32_bf16 v26, v117, v23, v26
v_dot2_f32_bf16 v27, v121, v23, v27
v_dot2_f32_bf16 v28, v118, v23, v28
v_dot2_f32_bf16 v29, v122, v23, v29
v_dot2_f32_bf16 v30, v119, v23, v30
v_dot2_f32_bf16 v31, v123, v23, v31
v_add_f32_dpp v24, v24, v24 row_ror:8 row_mask:0xf bank_mask:0x3
v_add_f32_dpp v26, v26, v26 row_ror:8 row_mask:0xf bank_mask:0x3
v_add_f32_dpp v28, v28, v28 row_ror:8 row_mask:0xf bank_mask:0x3
v_add_f32_dpp v30, v30, v30 row_ror:8 row_mask:0xf bank_mask:0x3
v_add_f32_dpp v24, v25, v25 row_ror:8 row_mask:0xf bank_mask:0xc
v_add_f32_dpp v26, v27, v27 row_ror:8 row_mask:0xf bank_mask:0xc
v_add_f32_dpp v28, v29, v29 row_ror:8 row_mask:0xf bank_mask:0xc
v_add_f32_dpp v30, v31, v31 row_ror:8 row_mask:0xf bank_mask:0xc
v_permlane16_swap_b32 v24, v26
s_nop 0
v_permlane16_swap_b32 v28, v30
v_add_f32 v24, v24, v26
v_add_f32 v28, v28, v30
s_nop 1
v_permlane32_swap_b32 v24, v28
v_add_f32 v24, v24, v28
ds_write_b32 v6, v24 offset:1024
s_mov_b64 exec, 1
v_mov_b32 v56, 0
v_mov_b32 v57, 1
ds_add_u32 v56, v57 offset:0
s_mov_b64 exec, -1
s_cmp_lg_u32 s31, 0
s_cbranch_scc1 L_h3
v_mov_b32 v56, 0
L_wf5:
ds_read_b32 v57, v56 offset:0
s_waitcnt lgkmcnt(0)
v_readfirstlane_b32 s3, v57
s_cmp_ge_u32 s3, 4
s_cbranch_scc1 L_wd6
s_sub_u32 s79, s79, 1
s_cbranch_scc0 L_wf5
s_mov_b32 s79, 0
L_wd6:
s_mov_b64 exec, 0xffff
ds_read_b128 v[24:27], v130 offset:1024
ds_read_b128 v[28:31], v130 offset:1280
ds_read_b128 v[32:35], v130 offset:1536
ds_read_b128 v[36:39], v130 offset:1792
s_waitcnt lgkmcnt(0)
v_add_f32 v24, v24, v28
v_add_f32 v32, v32, v36
v_add_f32 v25, v25, v29
v_add_f32 v33, v33, v37
v_add_f32 v26, v26, v30
v_add_f32 v34, v34, v38
v_add_f32 v27, v27, v31
v_add_f32 v35, v35, v39
v_add_f32 v24, v24, v32
v_add_f32 v25, v25, v33
v_add_f32 v26, v26, v34
v_add_f32 v27, v27, v35
v_cvt_pk_bf16_f32 v24, v24, v25
v_cvt_pk_bf16_f32 v26, v26, v27
v_mov_b32 v25, s46
v_mov_b32 v27, s46
s_lshl_b32 s3, s34, 8
s_add_u32 s3, s3, 16384
buffer_store_dwordx4 v[24:27], v131, s[16:19], s3 offen sc1
s_mov_b64 exec, -1
s_branch L_h1
L_r0:
s_cmp_ge_u32 s35, 4
s_cbranch_scc1 L_e2
s_lshr_b32 s38, s34, 3
s_lshl_b32 s36, s38, 19
s_and_b32 s3, s34, 7
s_lshl_b32 s3, s3, 7
s_add_u32 s36, s36, s3
s_mov_b32 s4, s56
s_mov_b32 s5, s57
s_mov_b32 s6, 4194304
s_mov_b32 s7, 0x20000
v_lshrrev_b32 v4, 3, v0
v_mul_u32_u24 v4, 16384, v4
v_add_u32 v4, v11, v4
s_add_u32 s3, s36, 0
buffer_load_dwordx4 v[64:67], v4, s[4:7], s3 offen nt
s_add_u32 s3, s36, 1024
buffer_load_dwordx4 v[68:71], v4, s[4:7], s3 offen nt
s_add_u32 s3, s36, 2048
buffer_load_dwordx4 v[72:75], v4, s[4:7], s3 offen nt
s_add_u32 s3, s36, 3072
buffer_load_dwordx4 v[76:79], v4, s[4:7], s3 offen nt
s_add_u32 s3, s36, 4096
buffer_load_dwordx4 v[80:83], v4, s[4:7], s3 offen nt
s_add_u32 s3, s36, 5120
buffer_load_dwordx4 v[84:87], v4, s[4:7], s3 offen nt
s_add_u32 s3, s36, 6144
buffer_load_dwordx4 v[88:91], v4, s[4:7], s3 offen nt
s_add_u32 s3, s36, 7168
buffer_load_dwordx4 v[92:95], v4, s[4:7], s3 offen nt
s_add_u32 s3, s36, 8192
buffer_load_dwordx4 v[96:99], v4, s[4:7], s3 offen nt
s_add_u32 s3, s36, 9216
buffer_load_dwordx4 v[100:103], v4, s[4:7], s3 offen nt
s_add_u32 s3, s36, 10240
buffer_load_dwordx4 v[104:107], v4, s[4:7], s3 offen nt
s_add_u32 s3, s36, 11264
buffer_load_dwordx4 v[108:111], v4, s[4:7], s3 offen nt
s_add_u32 s3, s36, 12288
buffer_load_dwordx4 v[112:115], v4, s[4:7], s3 offen nt
s_add_u32 s3, s36, 13312
buffer_load_dwordx4 v[116:119], v4, s[4:7], s3 offen nt
s_add_u32 s3, s36, 14336
buffer_load_dwordx4 v[120:123], v4, s[4:7], s3 offen nt
s_add_u32 s3, s36, 15360
buffer_load_dwordx4 v[124:127], v4, s[4:7], s3 offen nt
s_branch L_e3
L_e2:
s_cmp_lg_u32 s35, 6
s_cbranch_scc1 L_e3
s_lshl_b32 s36, s34, 7
s_mov_b32 s4, s60
s_mov_b32 s5, s61
s_mov_b32 s6, 1835008
s_mov_b32 s7, 0x20000
v_lshrrev_b32 v4, 3, v0
v_mul_u32_u24 v4, 57344, v4
v_add_u32 v4, v11, v4
s_add_u32 s3, s36, 0
buffer_load_dwordx4 v[64:67], v4, s[4:7], s3 offen nt
s_add_u32 s3, s36, 3584
buffer_load_dwordx4 v[68:71], v4, s[4:7], s3 offen nt
s_add_u32 s3, s36, 7168
buffer_load_dwordx4 v[72:75], v4, s[4:7], s3 offen nt
s_add_u32 s3, s36, 10752
buffer_load_dwordx4 v[76:79], v4, s[4:7], s3 offen nt
s_add_u32 s3, s36, 14336
buffer_load_dwordx4 v[80:83], v4, s[4:7], s3 offen nt
s_add_u32 s3, s36, 17920
buffer_load_dwordx4 v[84:87], v4, s[4:7], s3 offen nt
s_add_u32 s3, s36, 21504
buffer_load_dwordx4 v[88:91], v4, s[4:7], s3 offen nt
s_add_u32 s3, s36, 25088
buffer_load_dwordx4 v[92:95], v4, s[4:7], s3 offen nt
s_add_u32 s3, s36, 28672
buffer_load_dwordx4 v[96:99], v4, s[4:7], s3 offen nt
s_add_u32 s3, s36, 32256
buffer_load_dwordx4 v[100:103], v4, s[4:7], s3 offen nt
s_add_u32 s3, s36, 35840
buffer_load_dwordx4 v[104:107], v4, s[4:7], s3 offen nt
s_add_u32 s3, s36, 39424
buffer_load_dwordx4 v[108:111], v4, s[4:7], s3 offen nt
s_add_u32 s3, s36, 43008
buffer_load_dwordx4 v[112:115], v4, s[4:7], s3 offen nt
s_add_u32 s3, s36, 46592
buffer_load_dwordx4 v[116:119], v4, s[4:7], s3 offen nt
s_add_u32 s3, s36, 50176
buffer_load_dwordx4 v[120:123], v4, s[4:7], s3 offen nt
s_add_u32 s3, s36, 53760
buffer_load_dwordx4 v[124:127], v4, s[4:7], s3 offen nt
L_e3:
s_barrier
v_and_b32 v3, 1, v0
v_lshrrev_b32 v6, 3, v1
v_lshrrev_b32 v7, 1, v11
v_add_u32 v6, v6, v7
v_lshlrev_b32 v7, 4, v6
v_lshlrev_b32 v6, 2, v6
s_lshl_b32 s3, s31, 8
v_add_u32 v6, s3, v6
s_lshl_b32 s3, s31, 2
v_add_u32 v7, s3, v7
s_mov_b32 s28, 0x05040100
s_mov_b32 s29, 0x07060302
v_and_b32 v130, 0xff, v5
v_lshrrev_b32 v131, 4, v1
v_mul_u32_u24 v131, 20736, v131
v_add_u32 v131, v131, v130
s_and_b32 s25, s34, 0
s_mul_i32 s25, s25, 20736
s_add_u32 s25, s25, 0
s_waitcnt lgkmcnt(0)
s_mul_i32 s46, s46, 0x9e3779b1
s_add_u32 s46, s46, 0x7f4a7c15
s_cmp_lg_u32 s31, 0
s_cbranch_scc1 L_h3
L_h1:
v_and_b32 v4, 15, v1
v_lshlrev_b32 v10, 4, v4
v_lshlrev_b32 v4, 5, v4
s_lshl_b32 s37, s32, 9
s_add_u32 s37, s37, 16384
L_p7:
buffer_load_dwordx4 v[24:27], v4, s[16:19], s37 offen offset:0 sc1
buffer_load_dwordx4 v[28:31], v4, s[16:19], s37 offen offset:16 sc1
s_waitcnt vmcnt(0)
v_xor_b32 v25, s46, v25
v_xor_b32 v27, s46, v27
v_xor_b32 v29, s46, v29
v_xor_b32 v31, s46, v31
v_or_b32 v56, v25, v27
v_or3_b32 v56, v29, v31, v56
v_cmp_ne_u32 vcc, 0, v56
s_cbranch_vccz L_pd8
s_sleep 2
s_sub_u32 s79, s79, 1
s_cbranch_scc0 L_p7
s_mov_b32 s79, 0
L_pd8:
v_mov_b32 v25, v26
v_mov_b32 v26, v28
v_mov_b32 v27, v30
ds_write_b128 v10, v[24:27] offset:256
s_mov_b64 exec, 1
v_mov_b32 v56, 0
v_mov_b32 v57, 1
ds_add_u32 v56, v57 offset:12
s_mov_b64 exec, -1
L_h3:
v_lshlrev_b32 v10, 4, v0
v_mov_b32 v24, 0xff7fffff
v_mov_b32 v25, 0xff7fffff
v_mov_b32 v26, 0xff7fffff
v_mov_b32 v27, 0xff7fffff
v_add_u32 v4, 36864, v10
ds_write_b128 v4, v[24:27]
v_add_u32 v4, 40960, v10
ds_write_b128 v4, v[24:27]
v_add_u32 v4, 45056, v10
ds_write_b128 v4, v[24:27]
v_add_u32 v4, 49152, v10
ds_write_b128 v4, v[24:27]
v_add_u32 v4, 53248, v10
ds_write_b128 v4, v[24:27]
v_add_u32 v4, 57344, v10
ds_write_b128 v4, v[24:27]
v_add_u32 v4, 61440, v10
ds_write_b128 v4, v[24:27]
v_add_u32 v4, 65536, v10
ds_write_b128 v4, v[24:27]
v_add_u32 v4, 69632, v10
ds_write_b128 v4, v[24:27]
v_add_u32 v4, 73728, v10
ds_write_b128 v4, v[24:27]
v_add_u32 v4, 32768, v10
v_cmp_lt_u32 vcc, 3583, v10
s_cbranch_vccz L_npad
s_mov_b64 exec, vcc
ds_write_b128 v4, v[24:27]
s_mov_b64 exec, -1
L_npad:
s_mov_b64 exec, 1
v_mov_b32 v56, 0
v_mov_b32 v57, 1
ds_add_u32 v56, v57 offset:28
s_mov_b64 exec, -1
v_mov_b32 v56, 0
L_wf9:
ds_read_b32 v57, v56 offset:28
s_waitcnt lgkmcnt(0)
v_readfirstlane_b32 s3, v57
s_cmp_ge_u32 s3, 5
s_cbranch_scc1 L_wd10
s_sleep 8
s_sub_u32 s79, s79, 1
s_cbranch_scc0 L_wf9
s_mov_b32 s79, 0
L_wd10:
s_cmp_lg_u32 s31, 0
s_cbranch_scc1 L_h2
s_mov_b32 s4, s72
s_mov_b32 s5, s73
s_mov_b32 s6, 256
s_mov_b32 s7, 0x20000
s_and_b32 s3, s2, 3
s_lshl_b32 s3, s3, 6
v_mov_b32 v57, 1
s_mov_b64 exec, 1
buffer_atomic_add v57, v56, s[4:7], s3 offen sc1
s_mov_b64 exec, -1
v_lshlrev_b32 v4, 6, v1
L_arr:
s_sleep 64
buffer_load_dword v57, v4, s[4:7], 0 offen sc1
s_waitcnt vmcnt(0)
v_cmp_le_u32 vcc, 64, v57
s_cmp_eq_u32 vcc_lo, 15
s_cbranch_scc1 L_arrd
s_sub_u32 s79, s79, 1
s_cbranch_scc0 L_arr
s_mov_b32 s79, 0
L_arrd:
s_mov_b64 exec, 1
v_mov_b32 v56, 0
v_mov_b32 v57, 1
ds_add_u32 v56, v57 offset:8
s_mov_b64 exec, -1
s_cmp_lg_u32 s2, 0
s_cbranch_scc1 L_h2
v_mov_b32 v57, s46
s_mov_b32 s3, 36864
s_mov_b64 exec, 1
buffer_store_dword v57, v56, s[16:19], s3 offen sc1
s_mov_b64 exec, -1
L_h2:
s_cmp_lt_u32 s35, 2
s_cbranch_scc1 L_h4
s_cmp_ge_u32 s35, 4
s_cbranch_scc1 L_w2
s_lshr_b32 s38, s34, 3
s_lshl_b32 s36, s38, 19
s_and_b32 s3, s34, 7
s_lshl_b32 s3, s3, 7
s_add_u32 s36, s36, s3
s_waitcnt vmcnt(0)
v_perm_b32 v60, v68, v64, s28
v_perm_b32 v64, v68, v64, s29
v_perm_b32 v61, v69, v65, s28
v_perm_b32 v65, v69, v65, s29
v_perm_b32 v62, v70, v66, s28
v_perm_b32 v66, v70, v66, s29
v_perm_b32 v63, v71, v67, s28
v_perm_b32 v67, v71, v67, s29
v_perm_b32 v68, v76, v72, s28
v_perm_b32 v72, v76, v72, s29
v_perm_b32 v69, v77, v73, s28
v_perm_b32 v73, v77, v73, s29
v_perm_b32 v70, v78, v74, s28
v_perm_b32 v74, v78, v74, s29
v_perm_b32 v71, v79, v75, s28
v_perm_b32 v75, v79, v75, s29
v_perm_b32 v76, v84, v80, s28
v_perm_b32 v80, v84, v80, s29
v_perm_b32 v77, v85, v81, s28
v_perm_b32 v81, v85, v81, s29
v_perm_b32 v78, v86, v82, s28
v_perm_b32 v82, v86, v82, s29
v_perm_b32 v79, v87, v83, s28
v_perm_b32 v83, v87, v83, s29
v_perm_b32 v84, v92, v88, s28
v_perm_b32 v88, v92, v88, s29
v_perm_b32 v85, v93, v89, s28
v_perm_b32 v89, v93, v89, s29
v_perm_b32 v86, v94, v90, s28
v_perm_b32 v90, v94, v90, s29
v_perm_b32 v87, v95, v91, s28
v_perm_b32 v91, v95, v91, s29
v_perm_b32 v92, v100, v96, s28
v_perm_b32 v96, v100, v96, s29
v_perm_b32 v93, v101, v97, s28
v_perm_b32 v97, v101, v97, s29
v_perm_b32 v94, v102, v98, s28
v_perm_b32 v98, v102, v98, s29
v_perm_b32 v95, v103, v99, s28
v_perm_b32 v99, v103, v99, s29
v_perm_b32 v100, v108, v104, s28
v_perm_b32 v104, v108, v104, s29
v_perm_b32 v101, v109, v105, s28
v_perm_b32 v105, v109, v105, s29
v_perm_b32 v102, v110, v106, s28
v_perm_b32 v106, v110, v106, s29
v_perm_b32 v103, v111, v107, s28
v_perm_b32 v107, v111, v107, s29
v_perm_b32 v108, v116, v112, s28
v_perm_b32 v112, v116, v112, s29
v_perm_b32 v109, v117, v113, s28
v_perm_b32 v113, v117, v113, s29
v_perm_b32 v110, v118, v114, s28
v_perm_b32 v114, v118, v114, s29
v_perm_b32 v111, v119, v115, s28
v_perm_b32 v115, v119, v115, s29
v_perm_b32 v116, v124, v120, s28
v_perm_b32 v120, v124, v120, s29
v_perm_b32 v117, v125, v121, s28
v_perm_b32 v121, v125, v121, s29
v_perm_b32 v118, v126, v122, s28
v_perm_b32 v122, v126, v122, s29
v_perm_b32 v119, v127, v123, s28
v_perm_b32 v123, v127, v123, s29
s_branch L_h4
L_w2:
s_and_b32 s3, s35, 14
s_cmp_lg_u32 s3, 6
s_cbranch_scc1 L_h4
s_mov_b32 s8, s48
s_mov_b32 s9, s49
s_mov_b32 s10, 1024
s_mov_b32 s11, 0x20000
buffer_load_dwordx2 v[58:59], v9, s[8:11], 0 offen
s_and_b32 s39, s34, 15
s_lshl_b32 s39, s39, 7
s_add_u32 s40, s39, 10240
s_add_u32 s40, s40, s25
s_add_u32 s41, s25, 4096
s_add_u32 s42, s25, 8192
L_p11:
buffer_load_dwordx4 v[44:47], v2, s[16:19], s41 offen offset:0 sc1
buffer_load_dwordx4 v[48:51], v2, s[16:19], s41 offen offset:2048 sc1
buffer_load_dwordx4 v[52:55], v2, s[16:19], s42 offen offset:0 sc1
buffer_load_dwordx4 v[24:27], v11, s[16:19], s40 offen offset:0 sc1
s_waitcnt vmcnt(0)
v_xor_b32 v45, s46, v45
v_xor_b32 v47, s46, v47
v_xor_b32 v49, s46, v49
v_xor_b32 v51, s46, v51
v_xor_b32 v53, s46, v53
v_xor_b32 v55, s46, v55
v_xor_b32 v25, s46, v25
v_xor_b32 v27, s46, v27
v_or_b32 v56, v45, v47
v_or3_b32 v56, v49, v51, v56
v_or3_b32 v56, v53, v55, v56
v_or3_b32 v56, v25, v27, v56
v_cmp_ne_u32 vcc, 0, v56
s_cbranch_vccz L_pd12
s_sleep 8
s_sub_u32 s79, s79, 1
s_cbranch_scc0 L_p11
s_mov_b32 s79, 0
L_pd12:
v_and_b32 v45, s78, v44
v_and_b32 v47, s78, v46
v_and_b32 v49, s78, v48
v_and_b32 v51, s78, v50
v_and_b32 v53, s78, v52
v_and_b32 v55, s78, v54
v_and_b32 v25, s78, v24
v_and_b32 v27, s78, v26
v_lshlrev_b32 v44, 16, v44
v_lshlrev_b32 v46, 16, v46
v_lshlrev_b32 v48, 16, v48
v_lshlrev_b32 v50, 16, v50
v_lshlrev_b32 v52, 16, v52
v_lshlrev_b32 v54, 16, v54
v_lshlrev_b32 v24, 16, v24
v_lshlrev_b32 v26, 16, v26
v_add_f32 v52, 1.0, v52
v_add_f32 v53, 1.0, v53
v_add_f32 v54, 1.0, v54
v_add_f32 v55, 1.0, v55
v_cvt_pk_bf16_f32 v52, v52, v52
v_cvt_pk_bf16_f32 v53, v53, v53
v_cvt_pk_bf16_f32 v54, v54, v54
v_cvt_pk_bf16_f32 v55, v55, v55
v_lshlrev_b32 v52, 16, v52
v_lshlrev_b32 v53, 16, v53
v_lshlrev_b32 v54, 16, v54
v_lshlrev_b32 v55, 16, v55
v_lshlrev_b32 v40, 16, v58
v_and_b32 v41, s78, v58
v_lshlrev_b32 v42, 16, v59
v_and_b32 v43, s78, v59
s_cmp_eq_u32 s35, 6
s_cbranch_scc1 L_w3
v_mov_b32 v48, v24
v_mov_b32 v49, v25
v_mov_b32 v50, v26
v_mov_b32 v51, v27
s_branch L_h4
L_w3:
s_lshl_b32 s36, s34, 7
s_waitcnt vmcnt(0)
v_perm_b32 v60, v68, v64, s28
v_perm_b32 v64, v68, v64, s29
v_perm_b32 v61, v69, v65, s28
v_perm_b32 v65, v69, v65, s29
v_perm_b32 v62, v70, v66, s28
v_perm_b32 v66, v70, v66, s29
v_perm_b32 v63, v71, v67, s28
v_perm_b32 v67, v71, v67, s29
v_perm_b32 v68, v76, v72, s28
v_perm_b32 v72, v76, v72, s29
v_perm_b32 v69, v77, v73, s28
v_perm_b32 v73, v77, v73, s29
v_perm_b32 v70, v78, v74, s28
v_perm_b32 v74, v78, v74, s29
v_perm_b32 v71, v79, v75, s28
v_perm_b32 v75, v79, v75, s29
v_perm_b32 v76, v84, v80, s28
v_perm_b32 v80, v84, v80, s29
v_perm_b32 v77, v85, v81, s28
v_perm_b32 v81, v85, v81, s29
v_perm_b32 v78, v86, v82, s28
v_perm_b32 v82, v86, v82, s29
v_perm_b32 v79, v87, v83, s28
v_perm_b32 v83, v87, v83, s29
v_perm_b32 v84, v92, v88, s28
v_perm_b32 v88, v92, v88, s29
v_perm_b32 v85, v93, v89, s28
v_perm_b32 v89, v93, v89, s29
v_perm_b32 v86, v94, v90, s28
v_perm_b32 v90, v94, v90, s29
v_perm_b32 v87, v95, v91, s28
v_perm_b32 v91, v95, v91, s29
v_perm_b32 v92, v100, v96, s28
v_perm_b32 v96, v100, v96, s29
v_perm_b32 v93, v101, v97, s28
v_perm_b32 v97, v101, v97, s29
v_perm_b32 v94, v102, v98, s28
v_perm_b32 v98, v102, v98, s29
v_perm_b32 v95, v103, v99, s28
v_perm_b32 v99, v103, v99, s29
v_perm_b32 v100, v108, v104, s28
v_perm_b32 v104, v108, v104, s29
v_perm_b32 v101, v109, v105, s28
v_perm_b32 v105, v109, v105, s29
v_perm_b32 v102, v110, v106, s28
v_perm_b32 v106, v110, v106, s29
v_perm_b32 v103, v111, v107, s28
v_perm_b32 v107, v111, v107, s29
v_perm_b32 v108, v116, v112, s28
v_perm_b32 v112, v116, v112, s29
v_perm_b32 v109, v117, v113, s28
v_perm_b32 v113, v117, v113, s29
v_perm_b32 v110, v118, v114, s28
v_perm_b32 v114, v118, v114, s29
v_perm_b32 v111, v119, v115, s28
v_perm_b32 v115, v119, v115, s29
v_perm_b32 v116, v124, v120, s28
v_perm_b32 v120, v124, v120, s29
v_perm_b32 v117, v125, v121, s28
v_perm_b32 v121, v125, v121, s29
v_perm_b32 v118, v126, v122, s28
v_perm_b32 v122, v126, v122, s29
v_perm_b32 v119, v127, v123, s28
v_perm_b32 v123, v127, v123, s29
s_lshl_b32 s36, s34, 7
s_mov_b32 s4, s62
s_mov_b32 s5, s63
s_mov_b32 s6, 1835008
s_mov_b32 s7, 0x20000
v_lshrrev_b32 v4, 3, v0
v_mul_u32_u24 v4, 57344, v4
v_add_u32 v4, v11, v4
s_add_u32 s3, s36, 0
buffer_load_dwordx4 v[128:131], v4, s[4:7], s3 offen nt
s_add_u32 s3, s36, 3584
buffer_load_dwordx4 v[132:135], v4, s[4:7], s3 offen nt
s_add_u32 s3, s36, 7168
buffer_load_dwordx4 v[136:139], v4, s[4:7], s3 offen nt
s_add_u32 s3, s36, 10752
buffer_load_dwordx4 v[140:143], v4, s[4:7], s3 offen nt
s_add_u32 s3, s36, 14336
buffer_load_dwordx4 v[144:147], v4, s[4:7], s3 offen nt
s_add_u32 s3, s36, 17920
buffer_load_dwordx4 v[148:151], v4, s[4:7], s3 offen nt
s_add_u32 s3, s36, 21504
buffer_load_dwordx4 v[152:155], v4, s[4:7], s3 offen nt
s_add_u32 s3, s36, 25088
buffer_load_dwordx4 v[156:159], v4, s[4:7], s3 offen nt
s_add_u32 s3, s36, 28672
buffer_load_dwordx4 v[160:163], v4, s[4:7], s3 offen nt
s_add_u32 s3, s36, 32256
buffer_load_dwordx4 v[164:167], v4, s[4:7], s3 offen nt
s_add_u32 s3, s36, 35840
buffer_load_dwordx4 v[168:171], v4, s[4:7], s3 offen nt
s_add_u32 s3, s36, 39424
buffer_load_dwordx4 v[172:175], v4, s[4:7], s3 offen nt
s_add_u32 s3, s36, 43008
buffer_load_dwordx4 v[176:179], v4, s[4:7], s3 offen nt
s_add_u32 s3, s36, 46592
buffer_load_dwordx4 v[180:183], v4, s[4:7], s3 offen nt
s_add_u32 s3, s36, 50176
buffer_load_dwordx4 v[184:187], v4, s[4:7], s3 offen nt
s_add_u32 s3, s36, 53760
buffer_load_dwordx4 v[188:191], v4, s[4:7], s3 offen nt
s_waitcnt vmcnt(0)
v_perm_b32 v124, v132, v128, s28
v_perm_b32 v128, v132, v128, s29
v_perm_b32 v125, v133, v129, s28
v_perm_b32 v129, v133, v129, s29
v_perm_b32 v126, v134, v130, s28
v_perm_b32 v130, v134, v130, s29
v_perm_b32 v127, v135, v131, s28
v_perm_b32 v131, v135, v131, s29
v_perm_b32 v132, v140, v136, s28
v_perm_b32 v136, v140, v136, s29
v_perm_b32 v133, v141, v137, s28
v_perm_b32 v137, v141, v137, s29
v_perm_b32 v134, v142, v138, s28
v_perm_b32 v138, v142, v138, s29
v_perm_b32 v135, v143, v139, s28
v_perm_b32 v139, v143, v139, s29
v_perm_b32 v140, v148, v144, s28
v_perm_b32 v144, v148, v144, s29
v_perm_b32 v141, v149, v145, s28
v_perm_b32 v145, v149, v145, s29
v_perm_b32 v142, v150, v146, s28
v_perm_b32 v146, v150, v146, s29
v_perm_b32 v143, v151, v147, s28
v_perm_b32 v147, v151, v147, s29
v_perm_b32 v148, v156, v152, s28
v_perm_b32 v152, v156, v152, s29
v_perm_b32 v149, v157, v153, s28
v_perm_b32 v153, v157, v153, s29
v_perm_b32 v150, v158, v154, s28
v_perm_b32 v154, v158, v154, s29
v_perm_b32 v151, v159, v155, s28
v_perm_b32 v155, v159, v155, s29
v_perm_b32 v156, v164, v160, s28
v_perm_b32 v160, v164, v160, s29
v_perm_b32 v157, v165, v161, s28
v_perm_b32 v161, v165, v161, s29
v_perm_b32 v158, v166, v162, s28
v_perm_b32 v162, v166, v162, s29
v_perm_b32 v159, v167, v163, s28
v_perm_b32 v163, v167, v163, s29
v_perm_b32 v164, v172, v168, s28
v_perm_b32 v168, v172, v168, s29
v_perm_b32 v165, v173, v169, s28
v_perm_b32 v169, v173, v169, s29
v_perm_b32 v166, v174, v170, s28
v_perm_b32 v170, v174, v170, s29
v_perm_b32 v167, v175, v171, s28
v_perm_b32 v171, v175, v171, s29
v_perm_b32 v172, v180, v176, s28
v_perm_b32 v176, v180, v176, s29
v_perm_b32 v173, v181, v177, s28
v_perm_b32 v177, v181, v177, s29
v_perm_b32 v174, v182, v178, s28
v_perm_b32 v178, v182, v178, s29
v_perm_b32 v175, v183, v179, s28
v_perm_b32 v179, v183, v179, s29
v_perm_b32 v180, v188, v184, s28
v_perm_b32 v184, v188, v184, s29
v_perm_b32 v181, v189, v185, s28
v_perm_b32 v185, v189, v185, s29
v_perm_b32 v182, v190, v186, s28
v_perm_b32 v186, v190, v186, s29
v_perm_b32 v183, v191, v187, s28
v_perm_b32 v187, v191, v187, s29
L_h4:
v_mov_b32 v56, 0
L_wf13:
ds_read_b32 v57, v56 offset:16
s_waitcnt lgkmcnt(0)
v_readfirstlane_b32 s3, v57
s_cmp_ge_u32 s3, 4
s_cbranch_scc1 L_wd14
s_sleep 16
s_sub_u32 s79, s79, 1
s_cbranch_scc0 L_wf13
s_mov_b32 s79, 0
L_wd14:
ds_read_b128 v[12:15], v56 offset:80
s_waitcnt lgkmcnt(0)
v_max3_f32 v12, v12, v13, v14
v_max_f32 v12, v12, v15
v_mul_f32 v14, s27, v12
v_mov_b32 v13, 0
s_mul_i32 s37, s32, 40960
s_add_u32 s37, s37, 1011712
s_mov_b32 s43, 8192
L_scan:
v_add_u32 v4, s43, v10
ds_read_b128 v[24:27], v4
s_waitcnt lgkmcnt(0)
s_cmp_lt_u32 s43, 36864
s_cbranch_scc1 L_ns
v_cmp_ne_u32 vcc, 0xff7fffff, v24
s_and_saveexec_b64 s[44:45], vcc
s_cbranch_execz L_ns
buffer_store_dwordx4 v[24:27], v4, s[16:19], s37 offen sc1
L_ns:
s_mov_b64 exec, -1
v_fma_f32 v56, v24, s27, -v14
v_fma_f32 v57, v25, s27, -v14
v_fma_f32 v58, v26, s27, -v14
v_fma_f32 v59, v27, s27, -v14
v_exp_f32 v56, v56
v_exp_f32 v57, v57
v_exp_f32 v58, v58
v_exp_f32 v59, v59
v_add_f32 v13, v13, v56
v_add_f32 v13, v13, v57
v_add_f32 v13, v13, v58
v_add_f32 v13, v13, v59
s_add_u32 s43, s43, 4096
s_cmp_lt_u32 s43, 77824
s_cbranch_scc1 L_scan
v_add_f32_dpp v13, v13, v13 row_ror:8 row_mask:0xf bank_mask:0xf
s_nop 1
v_add_f32_dpp v13, v13, v13 row_ror:4 row_mask:0xf bank_mask:0xf
s_nop 1
v_add_f32_dpp v13, v13, v13 row_ror:2 row_mask:0xf bank_mask:0xf
s_nop 1
v_add_f32_dpp v13, v13, v13 row_ror:1 row_mask:0xf bank_mask:0xf
v_mov_b32 v56, v13
s_nop 1
v_permlane16_swap_b32 v13, v56
v_add_f32 v13, v13, v56
v_mov_b32 v56, v13
s_nop 1
v_permlane32_swap_b32 v13, v56
v_add_f32 v13, v13, v56
s_lshl_b32 s3, s31, 2
v_mov_b32 v4, s3
ds_write_b32 v4, v13 offset:96
s_waitcnt vmcnt(0)
s_mov_b64 exec, 1
v_mov_b32 v56, 0
v_mov_b32 v57, 1
ds_add_u32 v56, v57 offset:20
s_mov_b64 exec, -1
s_cmp_lg_u32 s31, 0
s_cbranch_scc1 L_h5
v_mov_b32 v56, 0
L_wf15:
ds_read_b32 v57, v56 offset:20
s_waitcnt lgkmcnt(0)
v_readfirstlane_b32 s3, v57
s_cmp_ge_u32 s3, 4
s_cbranch_scc1 L_wd16
s_sleep 1
s_sub_u32 s79, s79, 1
s_cbranch_scc0 L_wf15
s_mov_b32 s79, 0
L_wd16:
ds_read_b128 v[24:27], v56 offset:96
s_waitcnt lgkmcnt(0)
v_add_f32 v24, v24, v25
v_add_f32 v26, v26, v27
v_add_f32 v13, v24, v26
v_min_u32 v12, -2, v12
v_min_u32 v13, -2, v13
s_lshl_b32 s3, s2, 3
s_add_u32 s3, s3, 32768
s_mov_b64 exec, 1
buffer_store_dwordx2 v[12:13], v56, s[16:19], s3 offen sc1
s_mov_b64 exec, -1
v_lshrrev_b32 v4, 1, v11
s_lshl_b32 s37, s32, 6
s_add_u32 s37, s37, 32768
L_p17:
buffer_load_dwordx2 v[24:25], v4, s[16:19], s37 offen sc1
s_waitcnt vmcnt(0)
v_max_u32 v26, v24, v25
v_cmp_eq_u32 vcc, -1, v26
s_cbranch_vccz L_pd18
s_sleep 8
s_sub_u32 s79, s79, 1
s_cbranch_scc0 L_p17
s_mov_b32 s79, 0
L_pd18:
v_mov_b32 v26, v24
s_nop 1
v_max_f32_dpp v26, v26, v26 row_ror:4 row_mask:0xf bank_mask:0xf
s_nop 1
v_max_f32_dpp v26, v26, v26 row_ror:2 row_mask:0xf bank_mask:0xf
s_nop 1
v_max_f32_dpp v26, v26, v26 row_ror:1 row_mask:0xf bank_mask:0xf
v_sub_f32 v24, v24, v26
v_mul_f32 v24, s27, v24
v_exp_f32 v24, v24
s_nop 0
v_mul_f32 v24, v24, v25
s_nop 1
v_add_f32_dpp v24, v24, v24 row_ror:4 row_mask:0xf bank_mask:0xf
s_nop 1
v_add_f32_dpp v24, v24, v24 row_ror:2 row_mask:0xf bank_mask:0xf
s_nop 1
v_add_f32_dpp v24, v24, v24 row_ror:1 row_mask:0xf bank_mask:0xf
v_rcp_f32 v24, v24
ds_write_b32 v56, v26 offset:64
v_readfirstlane_b32 s30, v24
s_mov_b64 exec, 1
v_mov_b32 v56, 0
v_mov_b32 v57, 1
ds_add_u32 v56, v57 offset:24
s_mov_b64 exec, -1
L_h5:
s_cmp_lg_u32 s35, 6
s_cbranch_scc1 L_h6
s_mov_b32 s4, s64
s_mov_b32 s5, s65
s_mov_b32 s6, 1835008
s_mov_b32 s7, 0x20000
s_lshl_b32 s36, s34, 2
s_add_u32 s36, s36, s31
s_lshl_b32 s36, s36, 14
s_add_u32 s3, s36, 0
buffer_load_dwordx4 v[192:195], v5, s[4:7], s3 offen nt
s_add_u32 s3, s36, 1024
buffer_load_dwordx4 v[196:199], v5, s[4:7], s3 offen nt
s_add_u32 s3, s36, 2048
buffer_load_dwordx4 v[200:203], v5, s[4:7], s3 offen nt
s_add_u32 s3, s36, 3072
buffer_load_dwordx4 v[204:207], v5, s[4:7], s3 offen nt
s_add_u32 s3, s36, 4096
buffer_load_dwordx4 v[208:211], v5, s[4:7], s3 offen nt
s_add_u32 s3, s36, 5120
buffer_load_dwordx4 v[212:215], v5, s[4:7], s3 offen nt
s_add_u32 s3, s36, 6144
buffer_load_dwordx4 v[216:219], v5, s[4:7], s3 offen nt
s_add_u32 s3, s36, 7168
buffer_load_dwordx4 v[220:223], v5, s[4:7], s3 offen nt
s_add_u32 s3, s36, 8192
buffer_load_dwordx4 v[224:227], v5, s[4:7], s3 offen nt
s_add_u32 s3, s36, 9216
buffer_load_dwordx4 v[228:231], v5, s[4:7], s3 offen nt
s_add_u32 s3, s36, 10240
buffer_load_dwordx4 v[232:235], v5, s[4:7], s3 offen nt
s_add_u32 s3, s36, 11264
buffer_load_dwordx4 v[236:239], v5, s[4:7], s3 offen nt
s_add_u32 s3, s36, 12288
buffer_load_dwordx4 v[240:243], v5, s[4:7], s3 offen nt
s_add_u32 s3, s36, 13312
buffer_load_dwordx4 v[244:247], v5, s[4:7], s3 offen nt
s_add_u32 s3, s36, 14336
buffer_load_dwordx4 v[248:251], v5, s[4:7], s3 offen nt
s_add_u32 s3, s36, 15360
buffer_load_dwordx4 v[252:255], v5, s[4:7], s3 offen nt
s_waitcnt vmcnt(0)
v_perm_b32 v188, v196, v192, s28
v_perm_b32 v192, v196, v192, s29
v_perm_b32 v189, v197, v193, s28
v_perm_b32 v193, v197, v193, s29
v_perm_b32 v190, v198, v194, s28
v_perm_b32 v194, v198, v194, s29
v_perm_b32 v191, v199, v195, s28
v_perm_b32 v195, v199, v195, s29
v_perm_b32 v196, v204, v200, s28
v_perm_b32 v200, v204, v200, s29
v_perm_b32 v197, v205, v201, s28
v_perm_b32 v201, v205, v201, s29
v_perm_b32 v198, v206, v202, s28
v_perm_b32 v202, v206, v202, s29
v_perm_b32 v199, v207, v203, s28
v_perm_b32 v203, v207, v203, s29
v_perm_b32 v204, v212, v208, s28
v_perm_b32 v208, v212, v208, s29
v_perm_b32 v205, v213, v209, s28
v_perm_b32 v209, v213, v209, s29
v_perm_b32 v206, v214, v210, s28
v_perm_b32 v210, v214, v210, s29
v_perm_b32 v207, v215, v211, s28
v_perm_b32 v211, v215, v211, s29
v_perm_b32 v212, v220, v216, s28
v_perm_b32 v216, v220, v216, s29
v_perm_b32 v213, v221, v217, s28
v_perm_b32 v217, v221, v217, s29
v_perm_b32 v214, v222, v218, s28
v_perm_b32 v218, v222, v218, s29
v_perm_b32 v215, v223, v219, s28
v_perm_b32 v219, v223, v219, s29
v_perm_b32 v220, v228, v224, s28
v_perm_b32 v224, v228, v224, s29
v_perm_b32 v221, v229, v225, s28
v_perm_b32 v225, v229, v225, s29
v_perm_b32 v222, v230, v226, s28
v_perm_b32 v226, v230, v226, s29
v_perm_b32 v223, v231, v227, s28
v_perm_b32 v227, v231, v227, s29
v_perm_b32 v228, v236, v232, s28
v_perm_b32 v232, v236, v232, s29
v_perm_b32 v229, v237, v233, s28
v_perm_b32 v233, v237, v233, s29
v_perm_b32 v230, v238, v234, s28
v_perm_b32 v234, v238, v234, s29
v_perm_b32 v231, v239, v235, s28
v_perm_b32 v235, v239, v235, s29
v_perm_b32 v236, v244, v240, s28
v_perm_b32 v240, v244, v240, s29
v_perm_b32 v237, v245, v241, s28
v_perm_b32 v241, v245, v241, s29
v_perm_b32 v238, v246, v242, s28
v_perm_b32 v242, v246, v242, s29
v_perm_b32 v239, v247, v243, s28
v_perm_b32 v243, v247, v243, s29
v_perm_b32 v244, v252, v248, s28
v_perm_b32 v248, v252, v248, s29
v_perm_b32 v245, v253, v249, s28
v_perm_b32 v249, v253, v249, s29
v_perm_b32 v246, v254, v250, s28
v_perm_b32 v250, v254, v250, s29
v_perm_b32 v247, v255, v251, s28
v_perm_b32 v251, v255, v251, s29
L_h6:
v_and_b32 v8, 0x1ff, v2
v_lshl_add_u32 v8, v3, 11, v8
v_lshl_add_u32 v9, v3, 13, v2
v_lshrrev_b32 v10, 3, v0
v_lshl_add_u32 v10, v10, 11, v11
v_and_b32 v252, 15, v1
v_lshlrev_b32 v252, 4, v252
s_lshl_b32 s3, s31, 8
v_add_u32 v252, s3, v252
v_lshlrev_b32 v253, 5, v1
s_lshl_b32 s3, s31, 3
v_mov_b32 v254, s3
v_mov_b32 v255, 0
s_lshl_b32 s3, s31, 7
v_add_u32 v3, s3, v11
s_lshl_b32 s37, s38, 2
s_add_u32 s37, s37, s31
s_lshl_b32 s37, s37, 12
s_add_u32 s37, s37, 65536
s_lshl_b32 s40, s2, 9
s_add_u32 s40, s40, 65536
s_and_b32 s41, s34, 0
s_mul_i32 s41, s41, 20736
s_add_u32 s41, s41, 40960
s_add_u32 s42, s41, 4096
s_add_u32 s20, s74, 196608
s_addc_u32 s21, s75, 0
s_mov_b32 s23, 0x20000
s_mov_b32 s26, s18
s_mov_b32 s4, s70
s_mov_b32 s5, s71
s_mov_b32 s6, 0
s_mov_b32 s7, 0x20000
s_add_u32 s43, s39, 65536
s_add_u32 s44, s39, 131072
s_add_u32 s45, s39, 196608
s_mov_b32 s47, 1
L_tail:
s_cmp_eq_u32 s47, 0
s_cselect_b32 s18, s26, 0
s_cselect_b32 s22, 229376, 0
s_cselect_b32 s6, 1024, 0
s_waitcnt lgkmcnt(0)
s_cmp_lg_u32 s47, 0
s_cbranch_scc1 L_b19
s_barrier
L_b19:
s_cmp_lg_u32 s31, 0
s_cbranch_scc1 L_t1
s_mov_b32 exec_hi, 0
ds_read_b128 v[24:27], v5 offset:5120
ds_read_b128 v[28:31], v5 offset:5632
ds_read_b128 v[32:35], v5 offset:6144
ds_read_b128 v[36:39], v5 offset:6656
s_waitcnt lgkmcnt(0)
v_add_f32 v24, v24, v28
v_add_f32 v32, v32, v36
v_add_f32 v25, v25, v29
v_add_f32 v33, v33, v37
v_add_f32 v26, v26, v30
v_add_f32 v34, v34, v38
v_add_f32 v27, v27, v31
v_add_f32 v35, v35, v39
v_add_f32 v24, v24, v32
v_add_f32 v25, v25, v33
v_add_f32 v26, v26, v34
v_add_f32 v27, v27, v35
v_mul_f32 v56, s30, v24
v_mul_f32 v57, s30, v25
v_mul_f32 v58, s30, v26
v_mul_f32 v59, s30, v27
v_min_u32 v56, -2, v56
v_min_u32 v57, -2, v57
v_min_u32 v58, -2, v58
v_min_u32 v59, -2, v59
buffer_store_dwordx4 v[56:59], v5, s[16:19], s40 offen sc1
s_mov_b64 exec, -1
L_t1:
s_and_b32 s3, s35, 14
s_cmp_eq_u32 s3, 6
s_cbranch_scc1 L_t2
s_cmp_lg_u32 s3, 2
s_cbranch_scc1 L_fin
L_p20:
buffer_load_dwordx4 v[136:139], v8, s[16:19], s37 offen offset:0 sc1
buffer_load_dwordx4 v[140:143], v8, s[16:19], s37 offen offset:512 sc1
buffer_load_dwordx4 v[144:147], v8, s[16:19], s37 offen offset:1024 sc1
buffer_load_dwordx4 v[148:151], v8, s[16:19], s37 offen offset:1536 sc1
s_waitcnt vmcnt(0)
v_max_u32 v16, v136, v137
v_max3_u32 v16, v138, v139, v16
v_max3_u32 v16, v140, v141, v16
v_max3_u32 v16, v142, v143, v16
v_max3_u32 v16, v144, v145, v16
v_max3_u32 v16, v146, v147, v16
v_max3_u32 v16, v148, v149, v16
v_max3_u32 v16, v150, v151, v16
v_cmp_eq_u32 vcc, -1, v16
s_cbranch_vccz L_pd21
s_sub_u32 s79, s79, 1
s_cbranch_scc0 L_p20
s_mov_b32 s79, 0
L_pd21:
v_add_f32 v16, v136, v140
v_add_f32 v20, v144, v148
v_add_f32 v17, v137, v141
v_add_f32 v21, v145, v149
v_add_f32 v18, v138, v142
v_add_f32 v22, v146, v150
v_add_f32 v19, v139, v143
v_add_f32 v23, v147, v151
v_add_f32 v16, v16, v20
v_add_f32 v17, v17, v21
v_add_f32 v18, v18, v22
v_add_f32 v19, v19, v23
v_add_f32_dpp v12, v16, v16 quad_perm:[1,0,3,2] row_mask:0xf bank_mask:0xf
v_add_f32_dpp v13, v17, v17 quad_perm:[1,0,3,2] row_mask:0xf bank_mask:0xf
v_add_f32_dpp v14, v18, v18 quad_perm:[1,0,3,2] row_mask:0xf bank_mask:0xf
v_add_f32_dpp v15, v19, v19 quad_perm:[1,0,3,2] row_mask:0xf bank_mask:0xf
v_cvt_pk_bf16_f32 v12, v12, v13
v_cvt_pk_bf16_f32 v13, v14, v15
s_nop 0
v_mov_b32_dpp v16, v12 row_newbcast:0 row_mask:0xf bank_mask:0x3
v_mov_b32_dpp v17, v13 row_newbcast:0 row_mask:0xf bank_mask:0x3
v_mov_b32_dpp v18, v12 row_newbcast:2 row_mask:0xf bank_mask:0x3
v_mov_b32_dpp v19, v13 row_newbcast:2 row_mask:0xf bank_mask:0x3
v_mov_b32_dpp v20, v12 row_newbcast:4 row_mask:0xf bank_mask:0x3
v_mov_b32_dpp v21, v13 row_newbcast:4 row_mask:0xf bank_mask:0x3
v_mov_b32_dpp v22, v12 row_newbcast:6 row_mask:0xf bank_mask:0x3
v_mov_b32_dpp v23, v13 row_newbcast:6 row_mask:0xf bank_mask:0x3
v_mov_b32_dpp v16, v12 row_newbcast:8 row_mask:0xf bank_mask:0xc
v_mov_b32_dpp v17, v13 row_newbcast:8 row_mask:0xf bank_mask:0xc
v_mov_b32_dpp v18, v12 row_newbcast:10 row_mask:0xf bank_mask:0xc
v_mov_b32_dpp v19, v13 row_newbcast:10 row_mask:0xf bank_mask:0xc
v_mov_b32_dpp v20, v12 row_newbcast:12 row_mask:0xf bank_mask:0xc
v_mov_b32_dpp v21, v13 row_newbcast:12 row_mask:0xf bank_mask:0xc
v_mov_b32_dpp v22, v12 row_newbcast:14 row_mask:0xf bank_mask:0xc
v_mov_b32_dpp v23, v13 row_newbcast:14 row_mask:0xf bank_mask:0xc
v_dot2_f32_bf16 v24, v60, v16, 0
v_dot2_f32_bf16 v25, v64, v16, 0
v_dot2_f32_bf16 v26, v61, v16, 0
v_dot2_f32_bf16 v27, v65, v16, 0
v_dot2_f32_bf16 v28, v62, v16, 0
v_dot2_f32_bf16 v29, v66, v16, 0
v_dot2_f32_bf16 v30, v63, v16, 0
v_dot2_f32_bf16 v31, v67, v16, 0
v_dot2_f32_bf16 v24, v68, v17, v24
v_dot2_f32_bf16 v25, v72, v17, v25
v_dot2_f32_bf16 v26, v69, v17, v26
v_dot2_f32_bf16 v27, v73, v17, v27
v_dot2_f32_bf16 v28, v70, v17, v28
v_dot2_f32_bf16 v29, v74, v17, v29
v_dot2_f32_bf16 v30, v71, v17, v30
v_dot2_f32_bf16 v31, v75, v17, v31
v_dot2_f32_bf16 v24, v76, v18, v24
v_dot2_f32_bf16 v25, v80, v18, v25
v_dot2_f32_bf16 v26, v77, v18, v26
v_dot2_f32_bf16 v27, v81, v18, v27
v_dot2_f32_bf16 v28, v78, v18, v28
v_dot2_f32_bf16 v29, v82, v18, v29
v_dot2_f32_bf16 v30, v79, v18, v30
v_dot2_f32_bf16 v31, v83, v18, v31
v_dot2_f32_bf16 v24, v84, v19, v24
v_dot2_f32_bf16 v25, v88, v19, v25
v_dot2_f32_bf16 v26, v85, v19, v26
v_dot2_f32_bf16 v27, v89, v19, v27
v_dot2_f32_bf16 v28, v86, v19, v28
v_dot2_f32_bf16 v29, v90, v19, v29
v_dot2_f32_bf16 v30, v87, v19, v30
v_dot2_f32_bf16 v31, v91, v19, v31
v_dot2_f32_bf16 v24, v92, v20, v24
v_dot2_f32_bf16 v25, v96, v20, v25
v_dot2_f32_bf16 v26, v93, v20, v26
v_dot2_f32_bf16 v27, v97, v20, v27
v_dot2_f32_bf16 v28, v94, v20, v28
v_dot2_f32_bf16 v29, v98, v20, v29
v_dot2_f32_bf16 v30, v95, v20, v30
v_dot2_f32_bf16 v31, v99, v20, v31
v_dot2_f32_bf16 v24, v100, v21, v24
v_dot2_f32_bf16 v25, v104, v21, v25
v_dot2_f32_bf16 v26, v101, v21, v26
v_dot2_f32_bf16 v27, v105, v21, v27
v_dot2_f32_bf16 v28, v102, v21, v28
v_dot2_f32_bf16 v29, v106, v21, v29
v_dot2_f32_bf16 v30, v103, v21, v30
v_dot2_f32_bf16 v31, v107, v21, v31
v_dot2_f32_bf16 v24, v108, v22, v24
v_dot2_f32_bf16 v25, v112, v22, v25
v_dot2_f32_bf16 v26, v109, v22, v26
v_dot2_f32_bf16 v27, v113, v22, v27
v_dot2_f32_bf16 v28, v110, v22, v28
v_dot2_f32_bf16 v29, v114, v22, v29
v_dot2_f32_bf16 v30, v111, v22, v30
v_dot2_f32_bf16 v31, v115, v22, v31
v_dot2_f32_bf16 v24, v116, v23, v24
v_dot2_f32_bf16 v25, v120, v23, v25
v_dot2_f32_bf16 v26, v117, v23, v26
v_dot2_f32_bf16 v27, v121, v23, v27
v_dot2_f32_bf16 v28, v118, v23, v28
v_dot2_f32_bf16 v29, v122, v23, v29
v_dot2_f32_bf16 v30, v119, v23, v30
v_dot2_f32_bf16 v31, v123, v23, v31
v_add_f32_dpp v24, v24, v24 row_ror:8 row_mask:0xf bank_mask:0x3
v_add_f32_dpp v26, v26, v26 row_ror:8 row_mask:0xf bank_mask:0x3
v_add_f32_dpp v28, v28, v28 row_ror:8 row_mask:0xf bank_mask:0x3
v_add_f32_dpp v30, v30, v30 row_ror:8 row_mask:0xf bank_mask:0x3
v_add_f32_dpp v24, v25, v25 row_ror:8 row_mask:0xf bank_mask:0xc
v_add_f32_dpp v26, v27, v27 row_ror:8 row_mask:0xf bank_mask:0xc
v_add_f32_dpp v28, v29, v29 row_ror:8 row_mask:0xf bank_mask:0xc
v_add_f32_dpp v30, v31, v31 row_ror:8 row_mask:0xf bank_mask:0xc
v_permlane16_swap_b32 v24, v26
s_nop 0
v_permlane16_swap_b32 v28, v30
v_add_f32 v24, v24, v26
v_add_f32 v28, v28, v30
s_nop 1
v_permlane32_swap_b32 v24, v28
v_add_f32 v24, v24, v28
ds_write_b32 v6, v24 offset:1024
s_waitcnt lgkmcnt(0)
s_cmp_lg_u32 s47, 0
s_cbranch_scc1 L_b22
s_barrier
L_b22:
s_cmp_lg_u32 s31, 0
s_cbranch_scc1 L_fin
s_mov_b64 exec, 0xffff
ds_read_b128 v[24:27], v130 offset:1024
ds_read_b128 v[28:31], v130 offset:1280
ds_read_b128 v[32:35], v130 offset:1536
ds_read_b128 v[36:39], v130 offset:1792
s_waitcnt lgkmcnt(0)
v_add_f32 v24, v24, v28
v_add_f32 v32, v32, v36
v_add_f32 v25, v25, v29
v_add_f32 v33, v33, v37
v_add_f32 v26, v26, v30
v_add_f32 v34, v34, v38
v_add_f32 v27, v27, v31
v_add_f32 v35, v35, v39
v_add_f32 v24, v24, v32
v_add_f32 v25, v25, v33
v_add_f32 v26, v26, v34
v_add_f32 v27, v27, v35
v_min_u32 v24, -2, v24
v_min_u32 v25, -2, v25
v_min_u32 v26, -2, v26
v_min_u32 v27, -2, v27
s_lshl_b32 s3, s34, 8
s_add_u32 s3, s3, 40960
buffer_store_dwordx4 v[24:27], v131, s[16:19], s3 offen sc1
s_mov_b64 exec, -1
s_branch L_fin
L_t2:
L_p23:
buffer_load_dwordx4 v[24:27], v9, s[16:19], s41 offen offset:0 sc1
buffer_load_dwordx4 v[28:31], v9, s[16:19], s41 offen offset:2048 sc1
buffer_load_dwordx4 v[32:35], v9, s[16:19], s42 offen offset:0 sc1
buffer_load_dwordx4 v[36:39], v9, s[16:19], s42 offen offset:2048 sc1
s_waitcnt vmcnt(0)
v_max_u32 v16, v24, v25
v_max3_u32 v16, v26, v27, v16
v_max3_u32 v16, v28, v29, v16
v_max3_u32 v16, v30, v31, v16
v_max3_u32 v16, v32, v33, v16
v_max3_u32 v16, v34, v35, v16
v_max3_u32 v16, v36, v37, v16
v_max3_u32 v16, v38, v39, v16
v_cmp_eq_u32 vcc, -1, v16
s_cbranch_vccz L_pd24
s_sub_u32 s79, s79, 1
s_cbranch_scc0 L_p23
s_mov_b32 s79, 0
L_pd24:
v_add_f32 v16, v24, v28
v_add_f32 v20, v32, v36
v_add_f32 v17, v25, v29
v_add_f32 v21, v33, v37
v_add_f32 v18, v26, v30
v_add_f32 v22, v34, v38
v_add_f32 v19, v27, v31
v_add_f32 v23, v35, v39
v_add_f32 v16, v16, v20
v_add_f32 v17, v17, v21
v_add_f32 v18, v18, v22
v_add_f32 v19, v19, v23
v_add_f32_dpp v12, v16, v16 quad_perm:[1,0,3,2] row_mask:0xf bank_mask:0xf
v_add_f32_dpp v13, v17, v17 quad_perm:[1,0,3,2] row_mask:0xf bank_mask:0xf
v_add_f32_dpp v14, v18, v18 quad_perm:[1,0,3,2] row_mask:0xf bank_mask:0xf
v_add_f32_dpp v15, v19, v19 quad_perm:[1,0,3,2] row_mask:0xf bank_mask:0xf
v_cvt_pk_bf16_f32 v12, v12, v12
v_cvt_pk_bf16_f32 v13, v13, v13
v_cvt_pk_bf16_f32 v14, v14, v14
v_cvt_pk_bf16_f32 v15, v15, v15
v_lshlrev_b32 v12, 16, v12
v_lshlrev_b32 v13, 16, v13
v_lshlrev_b32 v14, 16, v14
v_lshlrev_b32 v15, 16, v15
v_mul_f32 v12, v12, v44
v_mul_f32 v13, v13, v45
v_mul_f32 v14, v14, v46
v_mul_f32 v15, v15, v47
v_cvt_pk_bf16_f32 v12, v12, v12
v_cvt_pk_bf16_f32 v13, v13, v13
v_cvt_pk_bf16_f32 v14, v14, v14
v_cvt_pk_bf16_f32 v15, v15, v15
v_lshlrev_b32 v12, 16, v12
v_lshlrev_b32 v13, 16, v13
v_lshlrev_b32 v14, 16, v14
v_lshlrev_b32 v15, 16, v15
v_add_f32 v12, v12, v40
v_add_f32 v13, v13, v41
v_add_f32 v14, v14, v42
v_add_f32 v15, v15, v43
v_cvt_pk_bf16_f32 v12, v12, v12
v_cvt_pk_bf16_f32 v13, v13, v13
v_cvt_pk_bf16_f32 v14, v14, v14
v_cvt_pk_bf16_f32 v15, v15, v15
v_lshlrev_b32 v12, 16, v12
v_lshlrev_b32 v13, 16, v13
v_lshlrev_b32 v14, 16, v14
v_lshlrev_b32 v15, 16, v15
s_cmp_eq_u32 s35, 7
s_cbranch_scc1 L_t3
v_add_f32 v56, v12, v13
v_add_f32 v57, v14, v15
v_add_f32 v56, v56, v57
s_nop 1
v_add_f32_dpp v56, v56, v56 row_ror:8 row_mask:0xf bank_mask:0xf
s_nop 1
v_add_f32_dpp v56, v56, v56 row_ror:4 row_mask:0xf bank_mask:0xf
s_nop 1
v_add_f32_dpp v56, v56, v56 row_ror:2 row_mask:0xf bank_mask:0xf
v_mov_b32 v57, v56
s_nop 1
v_permlane16_swap_b32 v56, v57
v_add_f32 v56, v56, v57
v_mov_b32 v57, v56
s_nop 1
v_permlane32_swap_b32 v56, v57
v_add_f32 v56, v56, v57
v_mul_f32 v56, 0x3c000000, v56
v_sub_f32 v16, v12, v56
v_sub_f32 v17, v13, v56
v_sub_f32 v18, v14, v56
v_sub_f32 v19, v15, v56
v_mul_f32 v57, v16, v16
v_mul_f32 v58, v17, v17
v_fmac_f32 v57, v18, v18
v_fmac_f32 v58, v19, v19
v_add_f32 v57, v57, v58
s_nop 1
v_add_f32_dpp v57, v57, v57 row_ror:8 row_mask:0xf bank_mask:0xf
s_nop 1
v_add_f32_dpp v57, v57, v57 row_ror:4 row_mask:0xf bank_mask:0xf
s_nop 1
v_add_f32_dpp v57, v57, v57 row_ror:2 row_mask:0xf bank_mask:0xf
v_mov_b32 v58, v57
s_nop 1
v_permlane16_swap_b32 v57, v58
v_add_f32 v57, v57, v58
v_mov_b32 v58, v57
s_nop 1
v_permlane32_swap_b32 v57, v58
v_add_f32 v57, v57, v58
ds_write_b64 v254, v[56:57] offset:512
s_waitcnt lgkmcnt(0)
s_cmp_lg_u32 s47, 0
s_cbranch_scc1 L_b25
s_barrier
L_b25:
ds_read_b128 v[16:19], v255 offset:512
ds_read_b128 v[20:23], v255 offset:528
s_waitcnt lgkmcnt(0)
v_add_f32 v56, v16, v18
v_add_f32 v58, v20, v22
v_add_f32 v57, v17, v19
v_add_f32 v59, v21, v23
v_add_f32 v56, v56, v58
v_add_f32 v57, v57, v59
v_mul_f32 v56, 0x3e800000, v56
v_mul_f32 v57, 0x3c000000, v57
v_sub_f32 v16, v16, v56
v_sub_f32 v18, v18, v56
v_sub_f32 v20, v20, v56
v_sub_f32 v22, v22, v56
v_fmac_f32 v57, v16, v16
v_fmac_f32 v57, v18, v18
v_fmac_f32 v57, v20, v20
v_fmac_f32 v57, v22, v22
v_mul_f32 v57, 0x3e800000, v57
v_cvt_pk_bf16_f32 v56, v56, v56
v_cvt_pk_bf16_f32 v57, v57, v57
v_lshlrev_b32 v56, 16, v56
v_lshlrev_b32 v57, 16, v57
v_add_f32 v57, 0x3727c5ac, v57
v_cvt_pk_bf16_f32 v57, v57, v57
v_lshlrev_b32 v57, 16, v57
v_sqrt_f32 v57, v57
s_nop 0
v_cvt_pk_bf16_f32 v57, v57, v57
v_lshlrev_b32 v57, 16, v57
v_rcp_f32 v58, v57
v_sub_f32 v12, v12, v56
v_sub_f32 v13, v13, v56
v_sub_f32 v14, v14, v56
v_sub_f32 v15, v15, v56
v_cvt_pk_bf16_f32 v12, v12, v12
v_cvt_pk_bf16_f32 v13, v13, v13
v_cvt_pk_bf16_f32 v14, v14, v14
v_cvt_pk_bf16_f32 v15, v15, v15
v_lshlrev_b32 v12, 16, v12
v_lshlrev_b32 v13, 16, v13
v_lshlrev_b32 v14, 16, v14
v_lshlrev_b32 v15, 16, v15
v_mul_f32 v16, v12, v58
v_mul_f32 v17, v13, v58
v_mul_f32 v18, v14, v58
v_mul_f32 v19, v15, v58
v_fma_f32 v12, -v16, v57, v12
v_fma_f32 v13, -v17, v57, v13
v_fma_f32 v14, -v18, v57, v14
v_fma_f32 v15, -v19, v57, v15
v_fma_f32 v12, v12, v58, v16
v_fma_f32 v13, v13, v58, v17
v_fma_f32 v14, v14, v58, v18
v_fma_f32 v15, v15, v58, v19
v_cvt_pk_bf16_f32 v12, v12, v12
v_cvt_pk_bf16_f32 v13, v13, v13
v_cvt_pk_bf16_f32 v14, v14, v14
v_cvt_pk_bf16_f32 v15, v15, v15
v_lshlrev_b32 v12, 16, v12
v_lshlrev_b32 v13, 16, v13
v_lshlrev_b32 v14, 16, v14
v_lshlrev_b32 v15, 16, v15
v_mul_f32 v12, v12, v52
v_mul_f32 v13, v13, v53
v_mul_f32 v14, v14, v54
v_mul_f32 v15, v15, v55
v_cvt_pk_bf16_f32 v12, v12, v12
v_cvt_pk_bf16_f32 v13, v13, v13
v_cvt_pk_bf16_f32 v14, v14, v14
v_cvt_pk_bf16_f32 v15, v15, v15
v_lshlrev_b32 v12, 16, v12
v_lshlrev_b32 v13, 16, v13
v_lshlrev_b32 v14, 16, v14
v_lshlrev_b32 v15, 16, v15
v_add_f32 v12, v12, v48
v_add_f32 v13, v13, v49
v_add_f32 v14, v14, v50
v_add_f32 v15, v15, v51
v_cvt_pk_bf16_f32 v12, v12, v13
v_cvt_pk_bf16_f32 v13, v14, v15
s_nop 0
v_mov_b32_dpp v16, v12 row_newbcast:0 row_mask:0xf bank_mask:0x3
v_mov_b32_dpp v17, v13 row_newbcast:0 row_mask:0xf bank_mask:0x3
v_mov_b32_dpp v18, v12 row_newbcast:2 row_mask:0xf bank_mask:0x3
v_mov_b32_dpp v19, v13 row_newbcast:2 row_mask:0xf bank_mask:0x3
v_mov_b32_dpp v20, v12 row_newbcast:4 row_mask:0xf bank_mask:0x3
v_mov_b32_dpp v21, v13 row_newbcast:4 row_mask:0xf bank_mask:0x3
v_mov_b32_dpp v22, v12 row_newbcast:6 row_mask:0xf bank_mask:0x3
v_mov_b32_dpp v23, v13 row_newbcast:6 row_mask:0xf bank_mask:0x3
v_mov_b32_dpp v16, v12 row_newbcast:8 row_mask:0xf bank_mask:0xc
v_mov_b32_dpp v17, v13 row_newbcast:8 row_mask:0xf bank_mask:0xc
v_mov_b32_dpp v18, v12 row_newbcast:10 row_mask:0xf bank_mask:0xc
v_mov_b32_dpp v19, v13 row_newbcast:10 row_mask:0xf bank_mask:0xc
v_mov_b32_dpp v20, v12 row_newbcast:12 row_mask:0xf bank_mask:0xc
v_mov_b32_dpp v21, v13 row_newbcast:12 row_mask:0xf bank_mask:0xc
v_mov_b32_dpp v22, v12 row_newbcast:14 row_mask:0xf bank_mask:0xc
v_mov_b32_dpp v23, v13 row_newbcast:14 row_mask:0xf bank_mask:0xc
s_waitcnt vmcnt(0)
v_dot2_f32_bf16 v24, v60, v16, 0
v_dot2_f32_bf16 v25, v64, v16, 0
v_dot2_f32_bf16 v26, v61, v16, 0
v_dot2_f32_bf16 v27, v65, v16, 0
v_dot2_f32_bf16 v28, v62, v16, 0
v_dot2_f32_bf16 v29, v66, v16, 0
v_dot2_f32_bf16 v30, v63, v16, 0
v_dot2_f32_bf16 v31, v67, v16, 0
v_dot2_f32_bf16 v24, v68, v17, v24
v_dot2_f32_bf16 v25, v72, v17, v25
v_dot2_f32_bf16 v26, v69, v17, v26
v_dot2_f32_bf16 v27, v73, v17, v27
v_dot2_f32_bf16 v28, v70, v17, v28
v_dot2_f32_bf16 v29, v74, v17, v29
v_dot2_f32_bf16 v30, v71, v17, v30
v_dot2_f32_bf16 v31, v75, v17, v31
v_dot2_f32_bf16 v24, v76, v18, v24
v_dot2_f32_bf16 v25, v80, v18, v25
v_dot2_f32_bf16 v26, v77, v18, v26
v_dot2_f32_bf16 v27, v81, v18, v27
v_dot2_f32_bf16 v28, v78, v18, v28
v_dot2_f32_bf16 v29, v82, v18, v29
v_dot2_f32_bf16 v30, v79, v18, v30
v_dot2_f32_bf16 v31, v83, v18, v31
v_dot2_f32_bf16 v24, v84, v19, v24
v_dot2_f32_bf16 v25, v88, v19, v25
v_dot2_f32_bf16 v26, v85, v19, v26
v_dot2_f32_bf16 v27, v89, v19, v27
v_dot2_f32_bf16 v28, v86, v19, v28
v_dot2_f32_bf16 v29, v90, v19, v29
v_dot2_f32_bf16 v30, v87, v19, v30
v_dot2_f32_bf16 v31, v91, v19, v31
v_dot2_f32_bf16 v24, v92, v20, v24
v_dot2_f32_bf16 v25, v96, v20, v25
v_dot2_f32_bf16 v26, v93, v20, v26
v_dot2_f32_bf16 v27, v97, v20, v27
v_dot2_f32_bf16 v28, v94, v20, v28
v_dot2_f32_bf16 v29, v98, v20, v29
v_dot2_f32_bf16 v30, v95, v20, v30
v_dot2_f32_bf16 v31, v99, v20, v31
v_dot2_f32_bf16 v24, v100, v21, v24
v_dot2_f32_bf16 v25, v104, v21, v25
v_dot2_f32_bf16 v26, v101, v21, v26
v_dot2_f32_bf16 v27, v105, v21, v27
v_dot2_f32_bf16 v28, v102, v21, v28
v_dot2_f32_bf16 v29, v106, v21, v29
v_dot2_f32_bf16 v30, v103, v21, v30
v_dot2_f32_bf16 v31, v107, v21, v31
v_dot2_f32_bf16 v24, v108, v22, v24
v_dot2_f32_bf16 v25, v112, v22, v25
v_dot2_f32_bf16 v26, v109, v22, v26
v_dot2_f32_bf16 v27, v113, v22, v27
v_dot2_f32_bf16 v28, v110, v22, v28
v_dot2_f32_bf16 v29, v114, v22, v29
v_dot2_f32_bf16 v30, v111, v22, v30
v_dot2_f32_bf16 v31, v115, v22, v31
v_dot2_f32_bf16 v24, v116, v23, v24
v_dot2_f32_bf16 v25, v120, v23, v25
v_dot2_f32_bf16 v26, v117, v23, v26
v_dot2_f32_bf16 v27, v121, v23, v27
v_dot2_f32_bf16 v28, v118, v23, v28
v_dot2_f32_bf16 v29, v122, v23, v29
v_dot2_f32_bf16 v30, v119, v23, v30
v_dot2_f32_bf16 v31, v123, v23, v31
v_dot2_f32_bf16 v32, v124, v16, 0
v_dot2_f32_bf16 v33, v128, v16, 0
v_dot2_f32_bf16 v34, v125, v16, 0
v_dot2_f32_bf16 v35, v129, v16, 0
v_dot2_f32_bf16 v36, v126, v16, 0
v_dot2_f32_bf16 v37, v130, v16, 0
v_dot2_f32_bf16 v38, v127, v16, 0
v_dot2_f32_bf16 v39, v131, v16, 0
v_dot2_f32_bf16 v32, v132, v17, v32
v_dot2_f32_bf16 v33, v136, v17, v33
v_dot2_f32_bf16 v34, v133, v17, v34
v_dot2_f32_bf16 v35, v137, v17, v35
v_dot2_f32_bf16 v36, v134, v17, v36
v_dot2_f32_bf16 v37, v138, v17, v37
v_dot2_f32_bf16 v38, v135, v17, v38
v_dot2_f32_bf16 v39, v139, v17, v39
v_dot2_f32_bf16 v32, v140, v18, v32
v_dot2_f32_bf16 v33, v144, v18, v33
v_dot2_f32_bf16 v34, v141, v18, v34
v_dot2_f32_bf16 v35, v145, v18, v35
v_dot2_f32_bf16 v36, v142, v18, v36
v_dot2_f32_bf16 v37, v146, v18, v37
v_dot2_f32_bf16 v38, v143, v18, v38
v_dot2_f32_bf16 v39, v147, v18, v39
v_dot2_f32_bf16 v32, v148, v19, v32
v_dot2_f32_bf16 v33, v152, v19, v33
v_dot2_f32_bf16 v34, v149, v19, v34
v_dot2_f32_bf16 v35, v153, v19, v35
v_dot2_f32_bf16 v36, v150, v19, v36
v_dot2_f32_bf16 v37, v154, v19, v37
v_dot2_f32_bf16 v38, v151, v19, v38
v_dot2_f32_bf16 v39, v155, v19, v39
v_dot2_f32_bf16 v32, v156, v20, v32
v_dot2_f32_bf16 v33, v160, v20, v33
v_dot2_f32_bf16 v34, v157, v20, v34
v_dot2_f32_bf16 v35, v161, v20, v35
v_dot2_f32_bf16 v36, v158, v20, v36
v_dot2_f32_bf16 v37, v162, v20, v37
v_dot2_f32_bf16 v38, v159, v20, v38
v_dot2_f32_bf16 v39, v163, v20, v39
v_dot2_f32_bf16 v32, v164, v21, v32
v_dot2_f32_bf16 v33, v168, v21, v33
v_dot2_f32_bf16 v34, v165, v21, v34
v_dot2_f32_bf16 v35, v169, v21, v35
v_dot2_f32_bf16 v36, v166, v21, v36
v_dot2_f32_bf16 v37, v170, v21, v37
v_dot2_f32_bf16 v38, v167, v21, v38
v_dot2_f32_bf16 v39, v171, v21, v39
v_dot2_f32_bf16 v32, v172, v22, v32
v_dot2_f32_bf16 v33, v176, v22, v33
v_dot2_f32_bf16 v34, v173, v22, v34
v_dot2_f32_bf16 v35, v177, v22, v35
v_dot2_f32_bf16 v36, v174, v22, v36
v_dot2_f32_bf16 v37, v178, v22, v37
v_dot2_f32_bf16 v38, v175, v22, v38
v_dot2_f32_bf16 v39, v179, v22, v39
v_dot2_f32_bf16 v32, v180, v23, v32
v_dot2_f32_bf16 v33, v184, v23, v33
v_dot2_f32_bf16 v34, v181, v23, v34
v_dot2_f32_bf16 v35, v185, v23, v35
v_dot2_f32_bf16 v36, v182, v23, v36
v_dot2_f32_bf16 v37, v186, v23, v37
v_dot2_f32_bf16 v38, v183, v23, v38
v_dot2_f32_bf16 v39, v187, v23, v39
v_add_f32_dpp v24, v24, v24 row_ror:8 row_mask:0xf bank_mask:0x3
v_add_f32_dpp v26, v26, v26 row_ror:8 row_mask:0xf bank_mask:0x3
v_add_f32_dpp v28, v28, v28 row_ror:8 row_mask:0xf bank_mask:0x3
v_add_f32_dpp v30, v30, v30 row_ror:8 row_mask:0xf bank_mask:0x3
v_add_f32_dpp v24, v25, v25 row_ror:8 row_mask:0xf bank_mask:0xc
v_add_f32_dpp v26, v27, v27 row_ror:8 row_mask:0xf bank_mask:0xc
v_add_f32_dpp v28, v29, v29 row_ror:8 row_mask:0xf bank_mask:0xc
v_add_f32_dpp v30, v31, v31 row_ror:8 row_mask:0xf bank_mask:0xc
v_add_f32_dpp v32, v32, v32 row_ror:8 row_mask:0xf bank_mask:0x3
v_add_f32_dpp v34, v34, v34 row_ror:8 row_mask:0xf bank_mask:0x3
v_add_f32_dpp v36, v36, v36 row_ror:8 row_mask:0xf bank_mask:0x3
v_add_f32_dpp v38, v38, v38 row_ror:8 row_mask:0xf bank_mask:0x3
v_add_f32_dpp v32, v33, v33 row_ror:8 row_mask:0xf bank_mask:0xc
v_add_f32_dpp v34, v35, v35 row_ror:8 row_mask:0xf bank_mask:0xc
v_add_f32_dpp v36, v37, v37 row_ror:8 row_mask:0xf bank_mask:0xc
v_add_f32_dpp v38, v39, v39 row_ror:8 row_mask:0xf bank_mask:0xc
v_permlane16_swap_b32 v24, v26
v_permlane16_swap_b32 v28, v30
v_permlane16_swap_b32 v32, v34
v_permlane16_swap_b32 v36, v38
v_add_f32 v24, v24, v26
v_add_f32 v28, v28, v30
v_add_f32 v32, v32, v34
v_add_f32 v36, v36, v38
v_permlane32_swap_b32 v24, v28
s_nop 0
v_permlane32_swap_b32 v32, v36
v_add_f32 v24, v24, v28
v_add_f32 v32, v32, v36
ds_write_b32 v7, v24 offset:1024
ds_write_b32 v7, v32 offset:2048
s_waitcnt lgkmcnt(0)
s_cmp_lg_u32 s47, 0
s_cbranch_scc1 L_b26
s_barrier
L_b26:
ds_read_b128 v[24:27], v252 offset:1024
ds_read_b128 v[28:31], v252 offset:2048
s_waitcnt lgkmcnt(0)
v_add_f32 v24, v24, v25
v_add_f32 v26, v26, v27
v_add_f32 v28, v28, v29
v_add_f32 v30, v30, v31
v_add_f32 v24, v24, v26
v_add_f32 v28, v28, v30
v_cvt_pk_bf16_f32 v24, v24, v24
v_cvt_pk_bf16_f32 v28, v28, v28
v_lshlrev_b32 v24, 16, v24
v_lshlrev_b32 v28, 16, v28
v_mul_f32 v25, v24, v24
v_mul_f32 v25, 0x3d372713, v25
v_fma_f32 v25, v25, v24, v24
v_mul_f32 v25, 0xc0135761, v25
v_exp_f32 v25, v25
s_nop 0
v_add_f32 v25, 1.0, v25
v_rcp_f32 v25, v25
s_nop 0
v_mul_f32 v24, v24, v25
v_cvt_pk_bf16_f32 v24, v24, v24
v_lshlrev_b32 v24, 16, v24
v_mul_f32 v24, v24, v28
s_nop 1
v_mov_b32_dpp v25, v24 quad_perm:[1,1,3,3] row_mask:0xf bank_mask:0xf
v_cvt_pk_bf16_f32 v24, v24, v25
s_nop 1
v_mov_b32_dpp v16, v24 row_newbcast:0 row_mask:0xf bank_mask:0xf
v_mov_b32_dpp v17, v24 row_newbcast:2 row_mask:0xf bank_mask:0xf
v_mov_b32_dpp v18, v24 row_newbcast:4 row_mask:0xf bank_mask:0xf
v_mov_b32_dpp v19, v24 row_newbcast:6 row_mask:0xf bank_mask:0xf
v_mov_b32_dpp v20, v24 row_newbcast:8 row_mask:0xf bank_mask:0xf
v_mov_b32_dpp v21, v24 row_newbcast:10 row_mask:0xf bank_mask:0xf
v_mov_b32_dpp v22, v24 row_newbcast:12 row_mask:0xf bank_mask:0xf
v_mov_b32_dpp v23, v24 row_newbcast:14 row_mask:0xf bank_mask:0xf
v_dot2_f32_bf16 v24, v188, v16, 0
v_dot2_f32_bf16 v25, v192, v16, 0
v_dot2_f32_bf16 v26, v189, v16, 0
v_dot2_f32_bf16 v27, v193, v16, 0
v_dot2_f32_bf16 v28, v190, v16, 0
v_dot2_f32_bf16 v29, v194, v16, 0
v_dot2_f32_bf16 v30, v191, v16, 0
v_dot2_f32_bf16 v31, v195, v16, 0
v_dot2_f32_bf16 v24, v196, v17, v24
v_dot2_f32_bf16 v25, v200, v17, v25
v_dot2_f32_bf16 v26, v197, v17, v26
v_dot2_f32_bf16 v27, v201, v17, v27
v_dot2_f32_bf16 v28, v198, v17, v28
v_dot2_f32_bf16 v29, v202, v17, v29
v_dot2_f32_bf16 v30, v199, v17, v30
v_dot2_f32_bf16 v31, v203, v17, v31
v_dot2_f32_bf16 v24, v204, v18, v24
v_dot2_f32_bf16 v25, v208, v18, v25
v_dot2_f32_bf16 v26, v205, v18, v26
v_dot2_f32_bf16 v27, v209, v18, v27
v_dot2_f32_bf16 v28, v206, v18, v28
v_dot2_f32_bf16 v29, v210, v18, v29
v_dot2_f32_bf16 v30, v207, v18, v30
v_dot2_f32_bf16 v31, v211, v18, v31
v_dot2_f32_bf16 v24, v212, v19, v24
v_dot2_f32_bf16 v25, v216, v19, v25
v_dot2_f32_bf16 v26, v213, v19, v26
v_dot2_f32_bf16 v27, v217, v19, v27
v_dot2_f32_bf16 v28, v214, v19, v28
v_dot2_f32_bf16 v29, v218, v19, v29
v_dot2_f32_bf16 v30, v215, v19, v30
v_dot2_f32_bf16 v31, v219, v19, v31
v_dot2_f32_bf16 v24, v220, v20, v24
v_dot2_f32_bf16 v25, v224, v20, v25
v_dot2_f32_bf16 v26, v221, v20, v26
v_dot2_f32_bf16 v27, v225, v20, v27
v_dot2_f32_bf16 v28, v222, v20, v28
v_dot2_f32_bf16 v29, v226, v20, v29
v_dot2_f32_bf16 v30, v223, v20, v30
v_dot2_f32_bf16 v31, v227, v20, v31
v_dot2_f32_bf16 v24, v228, v21, v24
v_dot2_f32_bf16 v25, v232, v21, v25
v_dot2_f32_bf16 v26, v229, v21, v26
v_dot2_f32_bf16 v27, v233, v21, v27
v_dot2_f32_bf16 v28, v230, v21, v28
v_dot2_f32_bf16 v29, v234, v21, v29
v_dot2_f32_bf16 v30, v231, v21, v30
v_dot2_f32_bf16 v31, v235, v21, v31
v_dot2_f32_bf16 v24, v236, v22, v24
v_dot2_f32_bf16 v25, v240, v22, v25
v_dot2_f32_bf16 v26, v237, v22, v26
v_dot2_f32_bf16 v27, v241, v22, v27
v_dot2_f32_bf16 v28, v238, v22, v28
v_dot2_f32_bf16 v29, v242, v22, v29
v_dot2_f32_bf16 v30, v239, v22, v30
v_dot2_f32_bf16 v31, v243, v22, v31
v_dot2_f32_bf16 v24, v244, v23, v24
v_dot2_f32_bf16 v25, v248, v23, v25
v_dot2_f32_bf16 v26, v245, v23, v26
v_dot2_f32_bf16 v27, v249, v23, v27
v_dot2_f32_bf16 v28, v246, v23, v28
v_dot2_f32_bf16 v29, v250, v23, v29
v_dot2_f32_bf16 v30, v247, v23, v30
v_dot2_f32_bf16 v31, v251, v23, v31
v_min_u32 v24, -2, v24
v_min_u32 v25, -2, v25
v_min_u32 v26, -2, v26
v_min_u32 v27, -2, v27
v_min_u32 v28, -2, v28
v_min_u32 v29, -2, v29
v_min_u32 v30, -2, v30
v_min_u32 v31, -2, v31
s_lshr_b32 s3, s36, 3
buffer_store_dwordx4 v[24:27], v253, s[20:23], s3 offen sc1
buffer_store_dwordx4 v[28:31], v253, s[20:23], s3 offen offset:16 sc1
s_branch L_fin
L_t3:
ds_write_b128 v2, v[12:15] offset:3072
L_p27:
buffer_load_dwordx4 v[136:139], v10, s[20:23], s39 offen sc1
buffer_load_dwordx4 v[140:143], v10, s[20:23], s43 offen sc1
buffer_load_dwordx4 v[144:147], v10, s[20:23], s44 offen sc1
buffer_load_dwordx4 v[148:151], v10, s[20:23], s45 offen sc1
s_waitcnt vmcnt(0)
v_max_u32 v16, v136, v137
v_max3_u32 v16, v138, v139, v16
v_max3_u32 v16, v140, v141, v16
v_max3_u32 v16, v142, v143, v16
v_max3_u32 v16, v144, v145, v16
v_max3_u32 v16, v146, v147, v16
v_max3_u32 v16, v148, v149, v16
v_max3_u32 v16, v150, v151, v16
v_cmp_eq_u32 vcc, -1, v16
s_cbranch_vccz L_pd28
s_sub_u32 s79, s79, 1
s_cbranch_scc0 L_p27
s_mov_b32 s79, 0
L_pd28:
v_add_f32 v24, v136, v140
v_add_f32 v28, v144, v148
v_add_f32 v25, v137, v141
v_add_f32 v29, v145, v149
v_add_f32 v26, v138, v142
v_add_f32 v30, v146, v150
v_add_f32 v27, v139, v143
v_add_f32 v31, v147, v151
v_add_f32 v24, v24, v28
v_add_f32 v25, v25, v29
v_add_f32 v26, v26, v30
v_add_f32 v27, v27, v31
v_add_f32_dpp v24, v24, v24 row_ror:8 row_mask:0xf bank_mask:0xf
v_add_f32_dpp v25, v25, v25 row_ror:8 row_mask:0xf bank_mask:0xf
v_add_f32_dpp v26, v26, v26 row_ror:8 row_mask:0xf bank_mask:0xf
v_add_f32_dpp v27, v27, v27 row_ror:8 row_mask:0xf bank_mask:0xf
v_mov_b32 v28, v24
v_mov_b32 v29, v25
v_mov_b32 v30, v26
v_mov_b32 v31, v27
v_permlane16_swap_b32 v24, v28
v_permlane16_swap_b32 v25, v29
v_permlane16_swap_b32 v26, v30
v_permlane16_swap_b32 v27, v31
v_add_f32 v24, v24, v28
v_add_f32 v25, v25, v29
v_add_f32 v26, v26, v30
v_add_f32 v27, v27, v31
v_mov_b32 v28, v24
v_mov_b32 v29, v25
v_mov_b32 v30, v26
v_mov_b32 v31, v27
v_permlane32_swap_b32 v24, v28
v_permlane32_swap_b32 v25, v29
v_permlane32_swap_b32 v26, v30
v_permlane32_swap_b32 v27, v31
v_add_f32 v24, v24, v28
v_add_f32 v25, v25, v29
v_add_f32 v26, v26, v30
v_add_f32 v27, v27, v31
ds_write_b128 v3, v[24:27] offset:1024
s_waitcnt lgkmcnt(0)
s_cmp_lg_u32 s47, 0
s_cbranch_scc1 L_b29
s_barrier
L_b29:
s_cmp_lg_u32 s31, 0
s_cbranch_scc1 L_fin
v_add_u32 v4, s39, v11
ds_read_b128 v[24:27], v11 offset:1024
ds_read_b128 v[28:31], v11 offset:1152
ds_read_b128 v[32:35], v11 offset:1280
ds_read_b128 v[36:39], v11 offset:1408
ds_read_b128 v[12:15], v4 offset:3072
s_waitcnt lgkmcnt(0)
v_add_f32 v24, v24, v28
v_add_f32 v32, v32, v36
v_add_f32 v25, v25, v29
v_add_f32 v33, v33, v37
v_add_f32 v26, v26, v30
v_add_f32 v34, v34, v38
v_add_f32 v27, v27, v31
v_add_f32 v35, v35, v39
v_add_f32 v24, v24, v32
v_add_f32 v25, v25, v33
v_add_f32 v26, v26, v34
v_add_f32 v27, v27, v35
v_cvt_pk_bf16_f32 v24, v24, v24
v_cvt_pk_bf16_f32 v25, v25, v25
v_cvt_pk_bf16_f32 v26, v26, v26
v_cvt_pk_bf16_f32 v27, v27, v27
v_lshlrev_b32 v24, 16, v24
v_lshlrev_b32 v25, 16, v25
v_lshlrev_b32 v26, 16, v26
v_lshlrev_b32 v27, 16, v27
v_mul_f32 v24, v24, v48
v_mul_f32 v25, v25, v49
v_mul_f32 v26, v26, v50
v_mul_f32 v27, v27, v51
v_cvt_pk_bf16_f32 v24, v24, v24
v_cvt_pk_bf16_f32 v25, v25, v25
v_cvt_pk_bf16_f32 v26, v26, v26
v_cvt_pk_bf16_f32 v27, v27, v27
v_lshlrev_b32 v24, 16, v24
v_lshlrev_b32 v25, 16, v25
v_lshlrev_b32 v26, 16, v26
v_lshlrev_b32 v27, 16, v27
v_add_f32 v24, v24, v12
v_add_f32 v25, v25, v13
v_add_f32 v26, v26, v14
v_add_f32 v27, v27, v15
v_cvt_pk_bf16_f32 v24, v24, v25
v_cvt_pk_bf16_f32 v25, v26, v27
v_lshrrev_b32 v4, 1, v4
s_mov_b64 exec, 255
buffer_store_dwordx2 v[24:25], v4, s[4:7], 0 offen
s_mov_b64 exec, -1
L_fin:
s_waitcnt vmcnt(0)
s_cmp_lg_u32 s47, 0
s_mov_b32 s47, 0
s_cbranch_scc1 L_tail
s_endpgm
L_stream:
v_lshrrev_b32 v3, 1, v1
v_lshlrev_b32 v3, 2, v3
v_lshlrev_b32 v1, 4, v1
v_add_u32 v2, 4096, v1
s_lshl_b32 s3, s32, 24
s_add_u32 s8, s50, s3
s_addc_u32 s9, s51, 0
s_mov_b32 s10, 0x1000000
s_mov_b32 s11, 0x20000
s_add_u32 s12, s52, s3
s_addc_u32 s13, s53, 0
s_mov_b32 s14, 0x1000000
s_mov_b32 s15, 0x20000
s_mul_i32 s3, s32, 8704
s_add_u32 s3, s3, 524288
s_mov_b32 s30, s3
s_mul_i32 s4, s31, 1088
s_add_u32 s3, s3, s4
s_add_u32 s44, s74, s3
s_addc_u32 s45, s75, 0
s_mul_i32 s3, s32, 40960
s_add_u32 s3, s3, 1048576
s_add_u32 s20, s74, s3
s_addc_u32 s21, s75, 0
s_mov_b32 s22, 40960
s_mov_b32 s23, 0x20000
s_barrier
s_cmp_lg_u32 s31, 0
s_cbranch_scc1 L_noclr
v_mov_b32 v4, -1
v_mov_b32 v5, -1
v_mov_b32 v6, -1
v_mov_b32 v7, -1
v_mov_b32 v8, 0
v_lshrrev_b32 v9, 6, v1
v_mul_u32_u24 v9, 20736, v9
v_and_b32 v10, 48, v1
v_add_u32 v9, v9, v10
s_mov_b32 exec_lo, 15
s_mov_b32 exec_hi, 0
s_lshl_b32 s3, s2, 6
s_add_u32 s3, s3, 40960
buffer_store_dwordx4 v[4:7], v9, s[16:19], s3 offen sc1
s_mov_b64 exec, 1
s_lshl_b32 s3, s2, 3
s_add_u32 s3, s3, 32768
buffer_store_dwordx2 v[4:5], v1, s[16:19], s3 offen sc1
s_cmp_lg_u32 s33, 0
s_cbranch_scc1 L_notk
s_mov_b64 exec, 255
v_mul_u32_u24 v10, 68, v1
buffer_store_dword v8, v10, s[16:19], s30 offen sc1
L_notk:
s_mov_b32 exec_lo, -1
s_lshl_b32 s3, s2, 9
s_add_u32 s3, s3, 65536
buffer_store_dwordx4 v[4:7], v1, s[16:19], s3 offen sc1
s_mov_b64 exec, -1
s_lshl_b32 s3, s2, 10
s_add_u32 s3, s3, 196608
buffer_store_dwordx4 v[4:7], v1, s[16:19], s3 offen sc1
L_noclr:
s_lshl_b32 s24, s33, 2
s_add_u32 s24, s24, s31
s_lshl_b32 s24, s24, 13
s_mov_b32 s36, s24
v_and_b32 v2, 0xff, v1
v_bfe_u32 v4, v1, 8, 1
v_lshl_add_u32 v2, v4, 8, v2
v_bfe_u32 v4, v1, 9, 1
v_lshl_add_u32 v2, v4, 9, v2
s_lshr_b32 s4, s36, 18
s_lshr_b32 s5, s36, 15
s_and_b32 s47, s36, 0xfff00000
s_add_u32 s5, s5, s4
s_add_u32 s5, s5, s32
s_bfe_u32 s3, s36, 0x2000d
s_lshl_b32 s3, s3, 13
s_or_b32 s47, s47, s3
s_bfe_u32 s3, s5, 0x10000
s_lshl_b32 s3, s3, 11
s_or_b32 s47, s47, s3
s_bfe_u32 s3, s5, 0x10001
s_lshl_b32 s3, s3, 15
s_or_b32 s47, s47, s3
s_bfe_u32 s3, s5, 0x10002
s_lshl_b32 s3, s3, 17
s_or_b32 s47, s47, s3
s_bfe_u32 s3, s4, 0x20000
s_lshl_b32 s3, s3, 18
s_or_b32 s47, s47, s3
s_add_u32 s3, s47, 0
buffer_load_dwordx4 v[64:67], v2, s[8:11], s3 offen nt
s_add_u32 s3, s47, 1024
buffer_load_dwordx4 v[68:71], v2, s[8:11], s3 offen nt
s_add_u32 s3, s47, 65536
buffer_load_dwordx4 v[72:75], v2, s[8:11], s3 offen nt
s_add_u32 s3, s47, 66560
buffer_load_dwordx4 v[76:79], v2, s[8:11], s3 offen nt
s_add_u32 s3, s47, 4096
buffer_load_dwordx4 v[80:83], v2, s[8:11], s3 offen nt
s_add_u32 s3, s47, 5120
buffer_load_dwordx4 v[84:87], v2, s[8:11], s3 offen nt
s_add_u32 s3, s47, 69632
buffer_load_dwordx4 v[88:91], v2, s[8:11], s3 offen nt
s_add_u32 s3, s47, 70656
buffer_load_dwordx4 v[92:95], v2, s[8:11], s3 offen nt
s_add_u32 s36, s36, 0x40000
s_waitcnt vmcnt(4)
s_lshr_b32 s4, s36, 18
s_lshr_b32 s5, s36, 15
s_and_b32 s47, s36, 0xfff00000
s_add_u32 s5, s5, s4
s_add_u32 s5, s5, s32
s_bfe_u32 s3, s36, 0x2000d
s_lshl_b32 s3, s3, 13
s_or_b32 s47, s47, s3
s_bfe_u32 s3, s5, 0x10000
s_lshl_b32 s3, s3, 11
s_or_b32 s47, s47, s3
s_bfe_u32 s3, s5, 0x10001
s_lshl_b32 s3, s3, 15
s_or_b32 s47, s47, s3
s_bfe_u32 s3, s5, 0x10002
s_lshl_b32 s3, s3, 17
s_or_b32 s47, s47, s3
s_bfe_u32 s3, s4, 0x20000
s_lshl_b32 s3, s3, 18
s_or_b32 s47, s47, s3
s_add_u32 s3, s47, 0
buffer_load_dwordx4 v[96:99], v2, s[8:11], s3 offen nt
s_add_u32 s3, s47, 1024
buffer_load_dwordx4 v[100:103], v2, s[8:11], s3 offen nt
s_add_u32 s3, s47, 65536
buffer_load_dwordx4 v[104:107], v2, s[8:11], s3 offen nt
s_add_u32 s3, s47, 66560
buffer_load_dwordx4 v[108:111], v2, s[8:11], s3 offen nt
s_waitcnt vmcnt(4)
s_add_u32 s3, s47, 4096
buffer_load_dwordx4 v[112:115], v2, s[8:11], s3 offen nt
s_add_u32 s3, s47, 5120
buffer_load_dwordx4 v[116:119], v2, s[8:11], s3 offen nt
s_add_u32 s3, s47, 69632
buffer_load_dwordx4 v[120:123], v2, s[8:11], s3 offen nt
s_add_u32 s3, s47, 70656
buffer_load_dwordx4 v[124:127], v2, s[8:11], s3 offen nt
s_add_u32 s36, s36, 0x40000
s_waitcnt vmcnt(4)
s_lshr_b32 s4, s36, 18
s_lshr_b32 s5, s36, 15
s_and_b32 s47, s36, 0xfff00000
s_add_u32 s5, s5, s4
s_add_u32 s5, s5, s32
s_bfe_u32 s3, s36, 0x2000d
s_lshl_b32 s3, s3, 13
s_or_b32 s47, s47, s3
s_bfe_u32 s3, s5, 0x10000
s_lshl_b32 s3, s3, 11
s_or_b32 s47, s47, s3
s_bfe_u32 s3, s5, 0x10001
s_lshl_b32 s3, s3, 15
s_or_b32 s47, s47, s3
s_bfe_u32 s3, s5, 0x10002
s_lshl_b32 s3, s3, 17
s_or_b32 s47, s47, s3
s_bfe_u32 s3, s4, 0x20000
s_lshl_b32 s3, s3, 18
s_or_b32 s47, s47, s3
s_add_u32 s3, s47, 0
buffer_load_dwordx4 v[128:131], v2, s[8:11], s3 offen nt
s_add_u32 s3, s47, 1024
buffer_load_dwordx4 v[132:135], v2, s[8:11], s3 offen nt
s_add_u32 s3, s47, 65536
buffer_load_dwordx4 v[136:139], v2, s[8:11], s3 offen nt
s_add_u32 s3, s47, 66560
buffer_load_dwordx4 v[140:143], v2, s[8:11], s3 offen nt
s_waitcnt vmcnt(4)
s_add_u32 s3, s47, 4096
buffer_load_dwordx4 v[144:147], v2, s[8:11], s3 offen nt
s_add_u32 s3, s47, 5120
buffer_load_dwordx4 v[148:151], v2, s[8:11], s3 offen nt
s_add_u32 s3, s47, 69632
buffer_load_dwordx4 v[152:155], v2, s[8:11], s3 offen nt
s_add_u32 s3, s47, 70656
buffer_load_dwordx4 v[156:159], v2, s[8:11], s3 offen nt
s_add_u32 s36, s36, 0x40000
s_waitcnt vmcnt(4)
s_lshr_b32 s4, s36, 18
s_lshr_b32 s5, s36, 15
s_and_b32 s47, s36, 0xfff00000
s_add_u32 s5, s5, s4
s_add_u32 s5, s5, s32
s_bfe_u32 s3, s36, 0x2000d
s_lshl_b32 s3, s3, 13
s_or_b32 s47, s47, s3
s_bfe_u32 s3, s5, 0x10000
s_lshl_b32 s3, s3, 11
s_or_b32 s47, s47, s3
s_bfe_u32 s3, s5, 0x10001
s_lshl_b32 s3, s3, 15
s_or_b32 s47, s47, s3
s_bfe_u32 s3, s5, 0x10002
s_lshl_b32 s3, s3, 17
s_or_b32 s47, s47, s3
s_bfe_u32 s3, s4, 0x20000
s_lshl_b32 s3, s3, 18
s_or_b32 s47, s47, s3
s_add_u32 s3, s47, 0
buffer_load_dwordx4 v[160:163], v2, s[8:11], s3 offen nt
s_add_u32 s3, s47, 1024
buffer_load_dwordx4 v[164:167], v2, s[8:11], s3 offen nt
s_add_u32 s3, s47, 65536
buffer_load_dwordx4 v[168:171], v2, s[8:11], s3 offen nt
s_add_u32 s3, s47, 66560
buffer_load_dwordx4 v[172:175], v2, s[8:11], s3 offen nt
s_waitcnt vmcnt(4)
s_add_u32 s3, s47, 4096
buffer_load_dwordx4 v[176:179], v2, s[8:11], s3 offen nt
s_add_u32 s3, s47, 5120
buffer_load_dwordx4 v[180:183], v2, s[8:11], s3 offen nt
s_add_u32 s3, s47, 69632
buffer_load_dwordx4 v[184:187], v2, s[8:11], s3 offen nt
s_add_u32 s3, s47, 70656
buffer_load_dwordx4 v[188:191], v2, s[8:11], s3 offen nt
s_add_u32 s36, s36, 0x40000
s_mov_b32 s3, s24
s_mov_b32 s24, s36
s_mov_b32 s36, s3
s_waitcnt vmcnt(4)
s_lshr_b32 s4, s24, 18
s_lshr_b32 s5, s24, 15
s_and_b32 s47, s24, 0xfff00000
s_add_u32 s5, s5, s4
s_add_u32 s5, s5, s32
s_bfe_u32 s3, s24, 0x2000d
s_lshl_b32 s3, s3, 13
s_or_b32 s47, s47, s3
s_bfe_u32 s3, s5, 0x10000
s_lshl_b32 s3, s3, 11
s_or_b32 s47, s47, s3
s_bfe_u32 s3, s5, 0x10001
s_lshl_b32 s3, s3, 15
s_or_b32 s47, s47, s3
s_bfe_u32 s3, s5, 0x10002
s_lshl_b32 s3, s3, 17
s_or_b32 s47, s47, s3
s_bfe_u32 s3, s4, 0x20000
s_lshl_b32 s3, s3, 18
s_or_b32 s47, s47, s3
s_add_u32 s3, s47, 0
buffer_load_dwordx4 v[32:35], v2, s[8:11], s3 offen nt
s_add_u32 s3, s47, 1024
buffer_load_dwordx4 v[36:39], v2, s[8:11], s3 offen nt
s_add_u32 s3, s47, 65536
buffer_load_dwordx4 v[40:43], v2, s[8:11], s3 offen nt
s_add_u32 s3, s47, 66560
buffer_load_dwordx4 v[44:47], v2, s[8:11], s3 offen nt
s_waitcnt vmcnt(4)
s_add_u32 s3, s47, 4096
buffer_load_dwordx4 v[48:51], v2, s[8:11], s3 offen nt
s_add_u32 s3, s47, 5120
buffer_load_dwordx4 v[52:55], v2, s[8:11], s3 offen nt
s_add_u32 s3, s47, 69632
buffer_load_dwordx4 v[56:59], v2, s[8:11], s3 offen nt
s_add_u32 s3, s47, 70656
buffer_load_dwordx4 v[60:63], v2, s[8:11], s3 offen nt
v_and_b32 v4, 15, v0
v_lshlrev_b32 v21, 4, v4
v_and_b32 v5, 1, v0
v_lshlrev_b32 v5, 4, v5
v_mov_b32 v6, 0xffff
v_lshlrev_b32 v23, v5, v6
v_lshrrev_b32 v22, 1, v4
v_cmp_eq_u32 vcc, 0, v22
s_nop 1
v_cndmask_b32 v4, 0, v23, vcc
v_cmp_eq_u32 vcc, 1, v22
s_nop 1
v_cndmask_b32 v5, 0, v23, vcc
v_cmp_eq_u32 vcc, 2, v22
s_nop 1
v_cndmask_b32 v6, 0, v23, vcc
v_cmp_eq_u32 vcc, 3, v22
s_nop 1
v_cndmask_b32 v7, 0, v23, vcc
v_mov_b32 v20, 0xff800000
s_mul_i32 s37, s31, 7040
s_add_u32 s37, s37, 8192
s_add_u32 s39, s37, 512
s_mov_b32 s26, 0x3db504f3
s_mov_b32 s28, 0
s_cmp_eq_u32 s35, 6
s_cselect_b32 s34, 52, 55
s_cselect_b32 s30, 786432, 0
s_cbranch_scc0 L_nrk
v_add_u32 v22, s37, v1
s_mov_b32 exec_lo, 0xffffff
s_mov_b32 exec_hi, 0x0
v_mov_b32 v12, 0xff7fffff
v_mov_b32 v13, 0xff7fffff
v_mov_b32 v14, 0xff7fffff
v_mov_b32 v15, 0xff7fffff
ds_write_b128 v22, v[12:15] offset:6656
s_mov_b64 exec, -1
L_nrk:
s_sub_u32 s46, 6, s32
s_and_b32 s46, s46, 7
s_lshl2_add_u32 s46, s46, s31
s_lshl_b32 s46, s46, 13
s_add_u32 s46, s46, 0xff000000
s_cmp_lg_u32 s31, 0
s_cbranch_scc1 L_nocd
s_waitcnt vmcnt(0) lgkmcnt(0)
s_mov_b64 exec, 1
v_mov_b32 v22, 0
v_mov_b32 v23, 1
ds_add_u32 v22, v23 offset:28
s_mov_b64 exec, -1
L_nocd:
s_waitcnt vmcnt(0)
s_mov_b64 exec, 1
v_mov_b32 v22, 0
v_mov_b32 v23, 1
ds_add_u32 v22, v23 offset:12
s_mov_b64 exec, -1
v_mov_b32 v22, 0
L_wf30:
ds_read_b32 v23, v22 offset:12
s_waitcnt lgkmcnt(0)
v_readfirstlane_b32 s3, v23
s_cmp_ge_u32 s3, 5
s_cbranch_scc1 L_wd31
s_sleep 1
s_sub_u32 s79, s79, 1
s_cbranch_scc0 L_wf30
s_mov_b32 s79, 0
L_wd31:
ds_read_b128 v[8:11], v21 offset:256
s_mov_b32 s25, 5
s_mov_b32 s42, 0
L_A:
s_waitcnt lgkmcnt(0)
s_cmp_ge_u32 s25, s34
s_cbranch_scc1 L_dy32
s_cmp_eq_u32 s25, 8
s_cselect_b32 s3, s30, 0
s_add_u32 s24, s24, s3
s_add_u32 s24, s24, 0x40000
s_mov_b32 s40, s24
s_add_u32 s41, s39, 128
s_add_u32 s25, s25, 1
s_and_b32 s3, s25, 1
s_cbranch_scc1 L_ns36
s_add_u32 s28, s28, 4
s_mov_b64 exec, 1
v_mov_b32 v24, 0
v_mov_b32 v25, 1
ds_add_u32 v24, v25 offset:36
s_mov_b64 exec, -1
v_mov_b32 v24, 0
L_wf37:
ds_read_b32 v25, v24 offset:36
s_waitcnt lgkmcnt(0)
v_readfirstlane_b32 s3, v25
s_cmp_ge_u32 s3, s28
s_cbranch_scc1 L_wd38
s_sub_u32 s79, s79, 1
s_cbranch_scc0 L_wf37
s_mov_b32 s79, 0
L_wd38:
L_ns36:
s_cmp_lt_u32 s25, s34
s_cbranch_scc1 L_go35
s_mov_b32 s38, 0
v_mov_b32 v22, 0
L_wf39:
ds_read_b32 v23, v22 offset:8
s_waitcnt lgkmcnt(0)
v_readfirstlane_b32 s3, v23
s_cmp_ge_u32 s3, 1
s_cbranch_scc1 L_wd40
s_sleep 1
s_sub_u32 s79, s79, 1
s_cbranch_scc0 L_wf39
s_mov_b32 s79, 0
L_wd40:
s_branch L_rq34
L_dy32:
s_cmp_ge_u32 s38, 75
s_cbranch_scc1 L_fi33
s_lshl2_add_u32 s43, s38, s31
s_lshl_b32 s40, s43, 13
s_add_u32 s40, s40, 14417920
s_lshl_b32 s43, s43, 7
s_lshl_b32 s3, s38, 18
s_add_u32 s3, s3, s46
s_cmp_ge_u32 s38, 72
s_cselect_b32 s40, s3, s40
s_add_u32 s41, s43, 36864
s_add_u32 s38, s38, 1
s_sub_u32 s29, s29, 1
s_cmp_lg_u32 s29, 0
s_cbranch_scc1 L_go35
L_rq34:
s_cmp_lt_u32 s38, 44
s_cselect_b32 s29, 2, 1
s_mov_b32 s38, s29
s_atomic_add s38, s[44:45], 0 glc
s_branch L_go35
L_fi33:
s_mov_b32 s42, 1
s_mov_b32 s8, s12
s_mov_b32 s9, s13
s_mov_b32 s40, s36
L_go35:
s_waitcnt vmcnt(4)
v_dot2_f32_bf16 v12, v32, v8, 0
v_dot2_f32_bf16 v13, v36, v8, 0
v_dot2_f32_bf16 v14, v40, v8, 0
v_dot2_f32_bf16 v15, v44, v8, 0
v_dot2_f32_bf16 v12, v33, v9, v12
v_dot2_f32_bf16 v13, v37, v9, v13
v_dot2_f32_bf16 v14, v41, v9, v14
v_dot2_f32_bf16 v15, v45, v9, v15
v_dot2_f32_bf16 v12, v34, v10, v12
v_dot2_f32_bf16 v13, v38, v10, v13
v_dot2_f32_bf16 v14, v42, v10, v14
v_dot2_f32_bf16 v15, v46, v10, v15
v_dot2_f32_bf16 v12, v35, v11, v12
v_dot2_f32_bf16 v13, v39, v11, v13
v_dot2_f32_bf16 v14, v43, v11, v14
v_dot2_f32_bf16 v15, v47, v11, v15
s_lshr_b32 s4, s40, 18
s_lshr_b32 s5, s40, 15
s_and_b32 s47, s40, 0xfff00000
s_add_u32 s5, s5, s4
s_add_u32 s5, s5, s32
s_bfe_u32 s3, s40, 0x2000d
s_lshl_b32 s3, s3, 13
s_or_b32 s47, s47, s3
s_bfe_u32 s3, s5, 0x10000
s_lshl_b32 s3, s3, 11
s_or_b32 s47, s47, s3
s_bfe_u32 s3, s5, 0x10001
s_lshl_b32 s3, s3, 15
s_or_b32 s47, s47, s3
s_bfe_u32 s3, s5, 0x10002
s_lshl_b32 s3, s3, 17
s_or_b32 s47, s47, s3
s_bfe_u32 s3, s4, 0x20000
s_lshl_b32 s3, s3, 18
s_or_b32 s47, s47, s3
s_add_u32 s3, s47, 0
buffer_load_dwordx4 v[32:35], v2, s[8:11], s3 offen nt
s_add_u32 s3, s47, 1024
buffer_load_dwordx4 v[36:39], v2, s[8:11], s3 offen nt
s_add_u32 s3, s47, 65536
buffer_load_dwordx4 v[40:43], v2, s[8:11], s3 offen nt
s_add_u32 s3, s47, 66560
buffer_load_dwordx4 v[44:47], v2, s[8:11], s3 offen nt
s_waitcnt vmcnt(4)
v_dot2_f32_bf16 v16, v48, v8, 0
v_dot2_f32_bf16 v17, v52, v8, 0
v_dot2_f32_bf16 v18, v56, v8, 0
v_dot2_f32_bf16 v19, v60, v8, 0
v_dot2_f32_bf16 v16, v49, v9, v16
v_dot2_f32_bf16 v17, v53, v9, v17
v_dot2_f32_bf16 v18, v57, v9, v18
v_dot2_f32_bf16 v19, v61, v9, v19
v_dot2_f32_bf16 v16, v50, v10, v16
v_dot2_f32_bf16 v17, v54, v10, v17
v_dot2_f32_bf16 v18, v58, v10, v18
v_dot2_f32_bf16 v19, v62, v10, v19
v_dot2_f32_bf16 v16, v51, v11, v16
v_dot2_f32_bf16 v17, v55, v11, v17
v_dot2_f32_bf16 v18, v59, v11, v18
v_dot2_f32_bf16 v19, v63, v11, v19
s_add_u32 s3, s47, 4096
buffer_load_dwordx4 v[48:51], v2, s[8:11], s3 offen nt
s_add_u32 s3, s47, 5120
buffer_load_dwordx4 v[52:55], v2, s[8:11], s3 offen nt
s_add_u32 s3, s47, 69632
buffer_load_dwordx4 v[56:59], v2, s[8:11], s3 offen nt
s_add_u32 s3, s47, 70656
buffer_load_dwordx4 v[60:63], v2, s[8:11], s3 offen nt
v_add_f32_dpp v12, v12, v12 row_ror:8 row_mask:0xf bank_mask:0x3
v_add_f32_dpp v14, v14, v14 row_ror:8 row_mask:0xf bank_mask:0x3
v_add_f32_dpp v16, v16, v16 row_ror:8 row_mask:0xf bank_mask:0x3
v_add_f32_dpp v18, v18, v18 row_ror:8 row_mask:0xf bank_mask:0x3
v_add_f32_dpp v12, v13, v13 row_ror:8 row_mask:0xf bank_mask:0xc
v_add_f32_dpp v14, v15, v15 row_ror:8 row_mask:0xf bank_mask:0xc
v_add_f32_dpp v16, v17, v17 row_ror:8 row_mask:0xf bank_mask:0xc
v_add_f32_dpp v18, v19, v19 row_ror:8 row_mask:0xf bank_mask:0xc
v_add_f32_dpp v12, v12, v12 row_shl:4 row_mask:0xf bank_mask:0x5
v_add_f32_dpp v16, v16, v16 row_shl:4 row_mask:0xf bank_mask:0x5
s_nop 0
v_add_f32_dpp v12, v14, v14 row_shr:4 row_mask:0xf bank_mask:0xa
v_add_f32_dpp v16, v18, v18 row_shr:4 row_mask:0xf bank_mask:0xa
s_nop 0
v_add_f32_dpp v12, v12, v12 quad_perm:[2,3,0,1] row_mask:0xf bank_mask:0xf
v_add_f32_dpp v16, v16, v16 quad_perm:[2,3,0,1] row_mask:0xf bank_mask:0xf
v_cndmask_b32 v12, v12, v16, s[76:77]
s_nop 1
v_add_f32_dpp v12, v12, v12 quad_perm:[1,0,3,2] row_mask:0xf bank_mask:0xf
v_add_u32 v21, s39, v3
v_cvt_pk_bf16_f32 v12, v12, v12
v_lshlrev_b32 v12, 16, v12
v_mul_f32 v12, s26, v12
v_cvt_pk_bf16_f32 v12, v12, v12
v_lshlrev_b32 v12, 16, v12
ds_write_b32 v21, v12
v_max_f32 v20, v20, v12
s_mov_b32 s39, s41
s_cmp_lg_u32 s25, 6
s_cbranch_scc1 L_npre
v_add_u32 v21, s37, v3
v_dot2_f32_bf16 v12, v64, v8, 0
v_dot2_f32_bf16 v13, v68, v8, 0
v_dot2_f32_bf16 v14, v72, v8, 0
v_dot2_f32_bf16 v15, v76, v8, 0
v_dot2_f32_bf16 v16, v80, v8, 0
v_dot2_f32_bf16 v17, v84, v8, 0
v_dot2_f32_bf16 v18, v88, v8, 0
v_dot2_f32_bf16 v19, v92, v8, 0
v_dot2_f32_bf16 v12, v65, v9, v12
v_dot2_f32_bf16 v13, v69, v9, v13
v_dot2_f32_bf16 v14, v73, v9, v14
v_dot2_f32_bf16 v15, v77, v9, v15
v_dot2_f32_bf16 v16, v81, v9, v16
v_dot2_f32_bf16 v17, v85, v9, v17
v_dot2_f32_bf16 v18, v89, v9, v18
v_dot2_f32_bf16 v19, v93, v9, v19
v_dot2_f32_bf16 v12, v66, v10, v12
v_dot2_f32_bf16 v13, v70, v10, v13
v_dot2_f32_bf16 v14, v74, v10, v14
v_dot2_f32_bf16 v15, v78, v10, v15
v_dot2_f32_bf16 v16, v82, v10, v16
v_dot2_f32_bf16 v17, v86, v10, v17
v_dot2_f32_bf16 v18, v90, v10, v18
v_dot2_f32_bf16 v19, v94, v10, v19
v_dot2_f32_bf16 v12, v67, v11, v12
v_dot2_f32_bf16 v13, v71, v11, v13
v_dot2_f32_bf16 v14, v75, v11, v14
v_dot2_f32_bf16 v15, v79, v11, v15
v_dot2_f32_bf16 v16, v83, v11, v16
v_dot2_f32_bf16 v17, v87, v11, v17
v_dot2_f32_bf16 v18, v91, v11, v18
v_dot2_f32_bf16 v19, v95, v11, v19
v_dot2_f32_bf16 v24, v96, v8, 0
v_dot2_f32_bf16 v25, v100, v8, 0
v_dot2_f32_bf16 v26, v104, v8, 0
v_dot2_f32_bf16 v27, v108, v8, 0
v_dot2_f32_bf16 v28, v112, v8, 0
v_dot2_f32_bf16 v29, v116, v8, 0
v_dot2_f32_bf16 v30, v120, v8, 0
v_dot2_f32_bf16 v31, v124, v8, 0
v_dot2_f32_bf16 v24, v97, v9, v24
v_dot2_f32_bf16 v25, v101, v9, v25
v_dot2_f32_bf16 v26, v105, v9, v26
v_dot2_f32_bf16 v27, v109, v9, v27
v_dot2_f32_bf16 v28, v113, v9, v28
v_dot2_f32_bf16 v29, v117, v9, v29
v_dot2_f32_bf16 v30, v121, v9, v30
v_dot2_f32_bf16 v31, v125, v9, v31
v_dot2_f32_bf16 v24, v98, v10, v24
v_dot2_f32_bf16 v25, v102, v10, v25
v_dot2_f32_bf16 v26, v106, v10, v26
v_dot2_f32_bf16 v27, v110, v10, v27
v_dot2_f32_bf16 v28, v114, v10, v28
v_dot2_f32_bf16 v29, v118, v10, v29
v_dot2_f32_bf16 v30, v122, v10, v30
v_dot2_f32_bf16 v31, v126, v10, v31
v_dot2_f32_bf16 v24, v99, v11, v24
v_dot2_f32_bf16 v25, v103, v11, v25
v_dot2_f32_bf16 v26, v107, v11, v26
v_dot2_f32_bf16 v27, v111, v11, v27
v_dot2_f32_bf16 v28, v115, v11, v28
v_dot2_f32_bf16 v29, v119, v11, v29
v_dot2_f32_bf16 v30, v123, v11, v30
v_dot2_f32_bf16 v31, v127, v11, v31
v_add_f32_dpp v12, v12, v12 row_ror:8 row_mask:0xf bank_mask:0x3
v_add_f32_dpp v14, v14, v14 row_ror:8 row_mask:0xf bank_mask:0x3
v_add_f32_dpp v16, v16, v16 row_ror:8 row_mask:0xf bank_mask:0x3
v_add_f32_dpp v18, v18, v18 row_ror:8 row_mask:0xf bank_mask:0x3
v_add_f32_dpp v12, v13, v13 row_ror:8 row_mask:0xf bank_mask:0xc
v_add_f32_dpp v14, v15, v15 row_ror:8 row_mask:0xf bank_mask:0xc
v_add_f32_dpp v16, v17, v17 row_ror:8 row_mask:0xf bank_mask:0xc
v_add_f32_dpp v18, v19, v19 row_ror:8 row_mask:0xf bank_mask:0xc
v_add_f32_dpp v24, v24, v24 row_ror:8 row_mask:0xf bank_mask:0x3
v_add_f32_dpp v26, v26, v26 row_ror:8 row_mask:0xf bank_mask:0x3
v_add_f32_dpp v28, v28, v28 row_ror:8 row_mask:0xf bank_mask:0x3
v_add_f32_dpp v30, v30, v30 row_ror:8 row_mask:0xf bank_mask:0x3
v_add_f32_dpp v24, v25, v25 row_ror:8 row_mask:0xf bank_mask:0xc
v_add_f32_dpp v26, v27, v27 row_ror:8 row_mask:0xf bank_mask:0xc
v_add_f32_dpp v28, v29, v29 row_ror:8 row_mask:0xf bank_mask:0xc
v_add_f32_dpp v30, v31, v31 row_ror:8 row_mask:0xf bank_mask:0xc
v_add_f32_dpp v12, v12, v12 row_shl:4 row_mask:0xf bank_mask:0x5
v_add_f32_dpp v16, v16, v16 row_shl:4 row_mask:0xf bank_mask:0x5
s_nop 0
v_add_f32_dpp v12, v14, v14 row_shr:4 row_mask:0xf bank_mask:0xa
v_add_f32_dpp v16, v18, v18 row_shr:4 row_mask:0xf bank_mask:0xa
v_add_f32_dpp v24, v24, v24 row_shl:4 row_mask:0xf bank_mask:0x5
v_add_f32_dpp v28, v28, v28 row_shl:4 row_mask:0xf bank_mask:0x5
s_nop 0
v_add_f32_dpp v24, v26, v26 row_shr:4 row_mask:0xf bank_mask:0xa
v_add_f32_dpp v28, v30, v30 row_shr:4 row_mask:0xf bank_mask:0xa
v_add_f32_dpp v12, v12, v12 quad_perm:[2,3,0,1] row_mask:0xf bank_mask:0xf
v_add_f32_dpp v16, v16, v16 quad_perm:[2,3,0,1] row_mask:0xf bank_mask:0xf
v_add_f32_dpp v24, v24, v24 quad_perm:[2,3,0,1] row_mask:0xf bank_mask:0xf
v_add_f32_dpp v28, v28, v28 quad_perm:[2,3,0,1] row_mask:0xf bank_mask:0xf
v_cndmask_b32 v12, v12, v16, s[76:77]
v_cndmask_b32 v24, v24, v28, s[76:77]
s_nop 0
v_add_f32_dpp v12, v12, v12 quad_perm:[1,0,3,2] row_mask:0xf bank_mask:0xf
v_add_f32_dpp v24, v24, v24 quad_perm:[1,0,3,2] row_mask:0xf bank_mask:0xf
v_cvt_pk_bf16_f32 v12, v12, v12
v_cvt_pk_bf16_f32 v24, v24, v24
v_lshlrev_b32 v12, 16, v12
v_lshlrev_b32 v24, 16, v24
v_mul_f32 v12, s26, v12
v_mul_f32 v24, s26, v24
v_cvt_pk_bf16_f32 v12, v12, v12
v_cvt_pk_bf16_f32 v24, v24, v24
v_lshlrev_b32 v12, 16, v12
v_lshlrev_b32 v24, 16, v24
ds_write_b32 v21, v12 offset:0
v_max_f32 v20, v20, v12
ds_write_b32 v21, v24 offset:128
v_max_f32 v20, v20, v24
s_waitcnt lgkmcnt(0)
v_dot2_f32_bf16 v12, v128, v8, 0
v_dot2_f32_bf16 v13, v132, v8, 0
v_dot2_f32_bf16 v14, v136, v8, 0
v_dot2_f32_bf16 v15, v140, v8, 0
v_dot2_f32_bf16 v16, v144, v8, 0
v_dot2_f32_bf16 v17, v148, v8, 0
v_dot2_f32_bf16 v18, v152, v8, 0
v_dot2_f32_bf16 v19, v156, v8, 0
v_dot2_f32_bf16 v12, v129, v9, v12
v_dot2_f32_bf16 v13, v133, v9, v13
v_dot2_f32_bf16 v14, v137, v9, v14
v_dot2_f32_bf16 v15, v141, v9, v15
v_dot2_f32_bf16 v16, v145, v9, v16
v_dot2_f32_bf16 v17, v149, v9, v17
v_dot2_f32_bf16 v18, v153, v9, v18
v_dot2_f32_bf16 v19, v157, v9, v19
v_dot2_f32_bf16 v12, v130, v10, v12
v_dot2_f32_bf16 v13, v134, v10, v13
v_dot2_f32_bf16 v14, v138, v10, v14
v_dot2_f32_bf16 v15, v142, v10, v15
v_dot2_f32_bf16 v16, v146, v10, v16
v_dot2_f32_bf16 v17, v150, v10, v17
v_dot2_f32_bf16 v18, v154, v10, v18
v_dot2_f32_bf16 v19, v158, v10, v19
v_dot2_f32_bf16 v12, v131, v11, v12
v_dot2_f32_bf16 v13, v135, v11, v13
v_dot2_f32_bf16 v14, v139, v11, v14
v_dot2_f32_bf16 v15, v143, v11, v15
v_dot2_f32_bf16 v16, v147, v11, v16
v_dot2_f32_bf16 v17, v151, v11, v17
v_dot2_f32_bf16 v18, v155, v11, v18
v_dot2_f32_bf16 v19, v159, v11, v19
v_dot2_f32_bf16 v24, v160, v8, 0
v_dot2_f32_bf16 v25, v164, v8, 0
v_dot2_f32_bf16 v26, v168, v8, 0
v_dot2_f32_bf16 v27, v172, v8, 0
v_dot2_f32_bf16 v28, v176, v8, 0
v_dot2_f32_bf16 v29, v180, v8, 0
v_dot2_f32_bf16 v30, v184, v8, 0
v_dot2_f32_bf16 v31, v188, v8, 0
v_dot2_f32_bf16 v24, v161, v9, v24
v_dot2_f32_bf16 v25, v165, v9, v25
v_dot2_f32_bf16 v26, v169, v9, v26
v_dot2_f32_bf16 v27, v173, v9, v27
v_dot2_f32_bf16 v28, v177, v9, v28
v_dot2_f32_bf16 v29, v181, v9, v29
v_dot2_f32_bf16 v30, v185, v9, v30
v_dot2_f32_bf16 v31, v189, v9, v31
v_dot2_f32_bf16 v24, v162, v10, v24
v_dot2_f32_bf16 v25, v166, v10, v25
v_dot2_f32_bf16 v26, v170, v10, v26
v_dot2_f32_bf16 v27, v174, v10, v27
v_dot2_f32_bf16 v28, v178, v10, v28
v_dot2_f32_bf16 v29, v182, v10, v29
v_dot2_f32_bf16 v30, v186, v10, v30
v_dot2_f32_bf16 v31, v190, v10, v31
v_dot2_f32_bf16 v24, v163, v11, v24
v_dot2_f32_bf16 v25, v167, v11, v25
v_dot2_f32_bf16 v26, v171, v11, v26
v_dot2_f32_bf16 v27, v175, v11, v27
v_dot2_f32_bf16 v28, v179, v11, v28
v_dot2_f32_bf16 v29, v183, v11, v29
v_dot2_f32_bf16 v30, v187, v11, v30
v_dot2_f32_bf16 v31, v191, v11, v31
v_add_f32_dpp v12, v12, v12 row_ror:8 row_mask:0xf bank_mask:0x3
v_add_f32_dpp v14, v14, v14 row_ror:8 row_mask:0xf bank_mask:0x3
v_add_f32_dpp v16, v16, v16 row_ror:8 row_mask:0xf bank_mask:0x3
v_add_f32_dpp v18, v18, v18 row_ror:8 row_mask:0xf bank_mask:0x3
v_add_f32_dpp v12, v13, v13 row_ror:8 row_mask:0xf bank_mask:0xc
v_add_f32_dpp v14, v15, v15 row_ror:8 row_mask:0xf bank_mask:0xc
v_add_f32_dpp v16, v17, v17 row_ror:8 row_mask:0xf bank_mask:0xc
v_add_f32_dpp v18, v19, v19 row_ror:8 row_mask:0xf bank_mask:0xc
v_add_f32_dpp v24, v24, v24 row_ror:8 row_mask:0xf bank_mask:0x3
v_add_f32_dpp v26, v26, v26 row_ror:8 row_mask:0xf bank_mask:0x3
v_add_f32_dpp v28, v28, v28 row_ror:8 row_mask:0xf bank_mask:0x3
v_add_f32_dpp v30, v30, v30 row_ror:8 row_mask:0xf bank_mask:0x3
v_add_f32_dpp v24, v25, v25 row_ror:8 row_mask:0xf bank_mask:0xc
v_add_f32_dpp v26, v27, v27 row_ror:8 row_mask:0xf bank_mask:0xc
v_add_f32_dpp v28, v29, v29 row_ror:8 row_mask:0xf bank_mask:0xc
v_add_f32_dpp v30, v31, v31 row_ror:8 row_mask:0xf bank_mask:0xc
v_add_f32_dpp v12, v12, v12 row_shl:4 row_mask:0xf bank_mask:0x5
v_add_f32_dpp v16, v16, v16 row_shl:4 row_mask:0xf bank_mask:0x5
s_nop 0
v_add_f32_dpp v12, v14, v14 row_shr:4 row_mask:0xf bank_mask:0xa
v_add_f32_dpp v16, v18, v18 row_shr:4 row_mask:0xf bank_mask:0xa
v_add_f32_dpp v24, v24, v24 row_shl:4 row_mask:0xf bank_mask:0x5
v_add_f32_dpp v28, v28, v28 row_shl:4 row_mask:0xf bank_mask:0x5
s_nop 0
v_add_f32_dpp v24, v26, v26 row_shr:4 row_mask:0xf bank_mask:0xa
v_add_f32_dpp v28, v30, v30 row_shr:4 row_mask:0xf bank_mask:0xa
v_add_f32_dpp v12, v12, v12 quad_perm:[2,3,0,1] row_mask:0xf bank_mask:0xf
v_add_f32_dpp v16, v16, v16 quad_perm:[2,3,0,1] row_mask:0xf bank_mask:0xf
v_add_f32_dpp v24, v24, v24 quad_perm:[2,3,0,1] row_mask:0xf bank_mask:0xf
v_add_f32_dpp v28, v28, v28 quad_perm:[2,3,0,1] row_mask:0xf bank_mask:0xf
v_cndmask_b32 v12, v12, v16, s[76:77]
v_cndmask_b32 v24, v24, v28, s[76:77]
s_nop 0
v_add_f32_dpp v12, v12, v12 quad_perm:[1,0,3,2] row_mask:0xf bank_mask:0xf
v_add_f32_dpp v24, v24, v24 quad_perm:[1,0,3,2] row_mask:0xf bank_mask:0xf
v_cvt_pk_bf16_f32 v12, v12, v12
v_cvt_pk_bf16_f32 v24, v24, v24
v_lshlrev_b32 v12, 16, v12
v_lshlrev_b32 v24, 16, v24
v_mul_f32 v12, s26, v12
v_mul_f32 v24, s26, v24
v_cvt_pk_bf16_f32 v12, v12, v12
v_cvt_pk_bf16_f32 v24, v24, v24
v_lshlrev_b32 v12, 16, v12
v_lshlrev_b32 v24, 16, v24
ds_write_b32 v21, v12 offset:256
v_max_f32 v20, v20, v12
ds_write_b32 v21, v24 offset:384
v_max_f32 v20, v20, v24
s_waitcnt lgkmcnt(0)
L_npre:
s_cmp_eq_u32 s42, 0
s_cbranch_scc1 L_A
v_max_f32_dpp v20, v20, v20 row_ror:8 row_mask:0xf bank_mask:0xf
s_nop 1
v_max_f32_dpp v20, v20, v20 row_ror:4 row_mask:0xf bank_mask:0xf
s_nop 1
v_max_f32_dpp v20, v20, v20 row_ror:2 row_mask:0xf bank_mask:0xf
v_mov_b32 v21, v20
s_nop 1
v_permlane16_swap_b32 v20, v21
v_max_f32 v20, v20, v21
v_mov_b32 v21, v20
s_nop 1
v_permlane32_swap_b32 v20, v21
v_max_f32 v20, v20, v21
s_lshl_b32 s3, s31, 2
v_mov_b32 v21, s3
ds_write_b32 v21, v20 offset:80
s_mov_b64 exec, 1
v_mov_b32 v22, 0
v_mov_b32 v23, 1
ds_add_u32 v22, v23 offset:16
s_mov_b64 exec, -1
v_mul_f32 v20, s27, v20
v_add_u32 v21, s37, v3
v_mov_b32 v18, 0
v_mov_b32 v28, 0
v_mov_b32 v29, 0
v_mov_b32 v30, 0
v_mov_b32 v31, 0
ds_read_b32 v17, v21 offset:0
s_waitcnt lgkmcnt(0)
s_mov_b32 s25, 1
s_mov_b32 s42, 0
s_mov_b32 s24, s36
s_add_u32 s39, s37, 0
s_mov_b32 s43, 0x1000000
L_B:
s_waitcnt lgkmcnt(0)
s_cmp_ge_u32 s25, s34
s_cbranch_scc1 L_dy41
s_cmp_eq_u32 s25, 8
s_cselect_b32 s3, s30, 0
s_add_u32 s24, s24, s3
s_add_u32 s24, s24, 0x40000
s_mov_b32 s40, s24
s_add_u32 s41, s39, 128
s_add_u32 s25, s25, 1
s_and_b32 s3, s25, 1
s_cbranch_scc1 L_ns45
s_add_u32 s28, s28, 4
s_mov_b64 exec, 1
v_mov_b32 v24, 0
v_mov_b32 v25, 1
ds_add_u32 v24, v25 offset:36
s_mov_b64 exec, -1
v_mov_b32 v24, 0
L_wf46:
ds_read_b32 v25, v24 offset:36
s_waitcnt lgkmcnt(0)
v_readfirstlane_b32 s3, v25
s_cmp_ge_u32 s3, s28
s_cbranch_scc1 L_wd47
s_sub_u32 s79, s79, 1
s_cbranch_scc0 L_wf46
s_mov_b32 s79, 0
L_wd47:
L_ns45:
s_cmp_lt_u32 s25, s34
s_cbranch_scc1 L_go44
s_mov_b32 s38, 0
s_branch L_rq43
L_dy41:
s_cmp_gt_u32 s25, s34
s_cbranch_scc1 L_sk48
s_add_u32 s25, s25, 1
v_mov_b32 v24, 0
L_wf49:
ds_read_b32 v25, v24 offset:24
s_waitcnt lgkmcnt(0)
v_readfirstlane_b32 s3, v25
s_cmp_ge_u32 s3, 1
s_cbranch_scc1 L_wd50
s_sleep 1
s_sub_u32 s79, s79, 1
s_cbranch_scc0 L_wf49
s_mov_b32 s79, 0
L_wd50:
ds_read_b32 v25, v24 offset:64
s_waitcnt lgkmcnt(0)
v_mul_f32 v25, s27, v25
v_sub_f32 v24, v20, v25
v_exp_f32 v24, v24
v_mov_b32 v20, v25
v_mul_f32 v28, v28, v24
v_mul_f32 v29, v29, v24
v_mul_f32 v30, v30, v24
v_mul_f32 v31, v31, v24
L_sk48:
s_cmp_ge_u32 s38, 75
s_cbranch_scc1 L_fi42
s_lshl2_add_u32 s43, s38, s31
s_lshl_b32 s40, s43, 13
s_add_u32 s40, s40, 14417920
s_lshl_b32 s43, s43, 7
s_lshl_b32 s3, s38, 18
s_add_u32 s3, s3, s46
s_cmp_ge_u32 s38, 72
s_cselect_b32 s40, s3, s40
s_mov_b32 s41, 128
s_add_u32 s38, s38, 1
s_sub_u32 s29, s29, 1
s_cmp_lg_u32 s29, 0
s_cbranch_scc1 L_go44
L_rq43:
s_cmp_lt_u32 s38, 44
s_cselect_b32 s29, 2, 1
s_mov_b32 s38, s29
s_atomic_add s38, s[44:45], 4352 glc
s_branch L_go44
L_fi42:
s_mov_b32 s42, 1
s_mov_b32 s40, 0x1000000
s_mov_b32 s43, 0x1000000
L_go44:
s_waitcnt vmcnt(4)
v_add_f32 v16, v17, v18
v_add_u32 v21, s41, v3
v_fma_f32 v16, v16, s27, -v20
v_exp_f32 v16, v16
s_nop 0
v_cvt_pk_bf16_f32 v16, v16, v16
ds_read_b32 v17, v21
buffer_load_dword v18, v3, s[20:23], s43 offen sc1
v_and_b32_dpp v8, v16, v4 row_newbcast:0 row_mask:0xf bank_mask:0xf
v_and_b32_dpp v9, v16, v5 row_newbcast:0 row_mask:0xf bank_mask:0xf
v_and_b32_dpp v10, v16, v6 row_newbcast:0 row_mask:0xf bank_mask:0xf
v_and_b32_dpp v11, v16, v7 row_newbcast:0 row_mask:0xf bank_mask:0xf
v_and_b32_dpp v12, v16, v4 row_newbcast:8 row_mask:0xf bank_mask:0xf
v_and_b32_dpp v13, v16, v5 row_newbcast:8 row_mask:0xf bank_mask:0xf
v_and_b32_dpp v14, v16, v6 row_newbcast:8 row_mask:0xf bank_mask:0xf
v_and_b32_dpp v15, v16, v7 row_newbcast:8 row_mask:0xf bank_mask:0xf
v_mfma_f32_16x16x32_bf16 v[28:31], v[8:11], v[32:35], v[28:31]
v_and_b32_dpp v8, v16, v4 row_newbcast:4 row_mask:0xf bank_mask:0xf
v_and_b32_dpp v9, v16, v5 row_newbcast:4 row_mask:0xf bank_mask:0xf
v_and_b32_dpp v10, v16, v6 row_newbcast:4 row_mask:0xf bank_mask:0xf
v_and_b32_dpp v11, v16, v7 row_newbcast:4 row_mask:0xf bank_mask:0xf
v_mfma_f32_16x16x32_bf16 v[28:31], v[12:15], v[36:39], v[28:31]
v_and_b32_dpp v12, v16, v4 row_newbcast:12 row_mask:0xf bank_mask:0xf
v_and_b32_dpp v13, v16, v5 row_newbcast:12 row_mask:0xf bank_mask:0xf
v_and_b32_dpp v14, v16, v6 row_newbcast:12 row_mask:0xf bank_mask:0xf
v_and_b32_dpp v15, v16, v7 row_newbcast:12 row_mask:0xf bank_mask:0xf
v_mfma_f32_16x16x32_bf16 v[28:31], v[8:11], v[40:43], v[28:31]
s_nop 0
v_mfma_f32_16x16x32_bf16 v[28:31], v[12:15], v[44:47], v[28:31]
s_lshr_b32 s4, s40, 18
s_lshr_b32 s5, s40, 15
s_and_b32 s47, s40, 0xfff00000
s_add_u32 s5, s5, s4
s_add_u32 s5, s5, s32
s_bfe_u32 s3, s40, 0x2000d
s_lshl_b32 s3, s3, 13
s_or_b32 s47, s47, s3
s_bfe_u32 s3, s5, 0x10000
s_lshl_b32 s3, s3, 11
s_or_b32 s47, s47, s3
s_bfe_u32 s3, s5, 0x10001
s_lshl_b32 s3, s3, 15
s_or_b32 s47, s47, s3
s_bfe_u32 s3, s5, 0x10002
s_lshl_b32 s3, s3, 17
s_or_b32 s47, s47, s3
s_bfe_u32 s3, s4, 0x20000
s_lshl_b32 s3, s3, 18
s_or_b32 s47, s47, s3
s_add_u32 s3, s47, 0
buffer_load_dwordx4 v[32:35], v2, s[12:15], s3 offen nt
s_add_u32 s3, s47, 1024
buffer_load_dwordx4 v[36:39], v2, s[12:15], s3 offen nt
s_add_u32 s3, s47, 65536
buffer_load_dwordx4 v[40:43], v2, s[12:15], s3 offen nt
s_add_u32 s3, s47, 66560
buffer_load_dwordx4 v[44:47], v2, s[12:15], s3 offen nt
s_waitcnt vmcnt(5)
v_and_b32_dpp v8, v16, v4 row_newbcast:2 row_mask:0xf bank_mask:0xf
v_and_b32_dpp v9, v16, v5 row_newbcast:2 row_mask:0xf bank_mask:0xf
v_and_b32_dpp v10, v16, v6 row_newbcast:2 row_mask:0xf bank_mask:0xf
v_and_b32_dpp v11, v16, v7 row_newbcast:2 row_mask:0xf bank_mask:0xf
v_and_b32_dpp v12, v16, v4 row_newbcast:10 row_mask:0xf bank_mask:0xf
v_and_b32_dpp v13, v16, v5 row_newbcast:10 row_mask:0xf bank_mask:0xf
v_and_b32_dpp v14, v16, v6 row_newbcast:10 row_mask:0xf bank_mask:0xf
v_and_b32_dpp v15, v16, v7 row_newbcast:10 row_mask:0xf bank_mask:0xf
v_mfma_f32_16x16x32_bf16 v[28:31], v[8:11], v[48:51], v[28:31]
v_and_b32_dpp v8, v16, v4 row_newbcast:6 row_mask:0xf bank_mask:0xf
v_and_b32_dpp v9, v16, v5 row_newbcast:6 row_mask:0xf bank_mask:0xf
v_and_b32_dpp v10, v16, v6 row_newbcast:6 row_mask:0xf bank_mask:0xf
v_and_b32_dpp v11, v16, v7 row_newbcast:6 row_mask:0xf bank_mask:0xf
v_mfma_f32_16x16x32_bf16 v[28:31], v[12:15], v[52:55], v[28:31]
v_and_b32_dpp v12, v16, v4 row_newbcast:14 row_mask:0xf bank_mask:0xf
v_and_b32_dpp v13, v16, v5 row_newbcast:14 row_mask:0xf bank_mask:0xf
v_and_b32_dpp v14, v16, v6 row_newbcast:14 row_mask:0xf bank_mask:0xf
v_and_b32_dpp v15, v16, v7 row_newbcast:14 row_mask:0xf bank_mask:0xf
v_mfma_f32_16x16x32_bf16 v[28:31], v[8:11], v[56:59], v[28:31]
s_nop 0
v_mfma_f32_16x16x32_bf16 v[28:31], v[12:15], v[60:63], v[28:31]
s_add_u32 s3, s47, 4096
buffer_load_dwordx4 v[48:51], v2, s[12:15], s3 offen nt
s_add_u32 s3, s47, 5120
buffer_load_dwordx4 v[52:55], v2, s[12:15], s3 offen nt
s_add_u32 s3, s47, 69632
buffer_load_dwordx4 v[56:59], v2, s[12:15], s3 offen nt
s_add_u32 s3, s47, 70656
buffer_load_dwordx4 v[60:63], v2, s[12:15], s3 offen nt
s_mov_b32 s39, s41
s_cmp_eq_u32 s42, 0
s_cbranch_scc1 L_B
v_and_b32 v21, 15, v0
v_lshlrev_b32 v21, 5, v21
v_and_b32 v22, 16, v0
v_add_u32 v21, v21, v22
s_lshl_b32 s3, s31, 9
v_add_u32 v21, s3, v21
s_mov_b32 exec_hi, 0
ds_write_b128 v21, v[28:31] offset:5120
s_waitcnt lgkmcnt(0)
s_barrier
s_waitcnt vmcnt(0)
s_endpgm
L_end:
s_endpgm
.section .rodata,"a"
.p2align 6
.amdhsa_kernel adaLN_cond__mha_block_cached__geglu_ffn__decode_kernel
  .amdhsa_next_free_vgpr 256
  .amdhsa_next_free_sgpr 102
  .amdhsa_accum_offset 256
  .amdhsa_group_segment_fixed_size 0
  .amdhsa_kernarg_size 112
  .amdhsa_user_sgpr_count 2
  .amdhsa_user_sgpr_kernarg_segment_ptr 1
  .amdhsa_system_sgpr_workgroup_id_x 1
.end_amdhsa_kernel
```
